```python
import torch

def _softmax(x, axis=-1):
    return torch.softmax(x, dim=axis)
def _gelu(x):
    return torch.nn.functional.gelu(x, approximate="tanh")
def _silu(x):
    return torch.nn.functional.silu(x)
def _sigmoid(x):
    return torch.sigmoid(x)
def _layernorm(x, axis=-1, eps=1e-5):
    m = x.mean(dim=axis, keepdim=True)
    v = x.var(dim=axis, keepdim=True, unbiased=False)
    return (x - m) / torch.sqrt(v + eps)
def _scatter_add(tgt, idx, src, axis=0):
    return tgt.clone().index_add_(axis, idx, src)
def _segment_sum(src, seg, n):
    out = torch.zeros((n,) + src.shape[1:], dtype=src.dtype)
    return out.index_add_(0, seg, src)
def _pad(x, pw):
    flat = tuple(v for pair in reversed(pw) for v in pair)
    return torch.nn.functional.pad(x, flat)

kernel_name = 'gated_mix__ssm_conv_s5__glu_gated_swiglu__prompt'

def setup_inputs():

    _w = (lambda a: (lambda t: t.to(torch.bfloat16) if t.is_floating_point() else t)(torch.as_tensor(a)))
    def _A_setup():
        B, S, D = 1, 2048, 1024
        P = D
        Lambda_re = -0.5 * (lambda _x: torch.exp(torch.as_tensor(_x)))((lambda *s: torch.randn(*s, dtype=torch.bfloat16) * 0.2)(P))
        Lambda_im = (lambda *s: torch.randn(*s, dtype=torch.bfloat16) * 0.4)(P) * 1.0
        B_re = (lambda *s: torch.randn(*s, dtype=torch.bfloat16) * 0.2)(P, D) * (D ** -0.5)
        B_im = (lambda *s: torch.randn(*s, dtype=torch.bfloat16) * 0.2)(P, D) * (D ** -0.5)
        C_re = (lambda *s: torch.randn(*s, dtype=torch.bfloat16) * 0.2)(D, P) * (P ** -0.5)
        C_im = (lambda *s: torch.randn(*s, dtype=torch.bfloat16) * 0.2)(D, P) * (P ** -0.5)
        log_dt = (lambda *s: torch.randn(*s, dtype=torch.bfloat16) * 0.2)(P) * 0.3 - 2.0
        Dskip = (lambda *s: torch.randn(*s, dtype=torch.bfloat16) * 0.05)(D)
        return {
            "x": _w((lambda *s: torch.randn(*s, dtype=torch.bfloat16) * 0.05)(B, S, D)),
            "Lambda_re": _w(Lambda_re),
            "Lambda_im": _w(Lambda_im),
            "B_re": _w(B_re),
            "B_im": _w(B_im),
            "C_re": _w(C_re),
            "C_im": _w(C_im),
            "log_dt": _w(log_dt),
            "Dskip": _w(Dskip),
        }
    _A_in = _A_setup()

    def _B_setup():
        B, S, D, F = 1, 2048, 1024, 3584
        return {
            "x": _w((lambda *s: torch.randn(*s, dtype=torch.bfloat16) * 0.05)(B, S, D)),
            "w1": _w((lambda *s: torch.randn(*s, dtype=torch.bfloat16) * 0.8)(D, F) * (2.0 / D) ** 0.5),
            "w3": _w((lambda *s: torch.randn(*s, dtype=torch.bfloat16) * 0.8)(D, F) * (2.0 / D) ** 0.5),
            "w2": _w((lambda *s: torch.randn(*s, dtype=torch.bfloat16) * 0.8)(F, D) * (2.0 / F) ** 0.5),
        }
    _B_in = _B_setup()

    return {
        "A_x": _A_in["x"],
        "A_Lambda_re": _A_in["Lambda_re"],
        "A_Lambda_im": _A_in["Lambda_im"],
        "A_B_re": _A_in["B_re"],
        "A_B_im": _A_in["B_im"],
        "A_C_re": _A_in["C_re"],
        "A_C_im": _A_in["C_im"],
        "A_log_dt": _A_in["log_dt"],
        "A_Dskip": _A_in["Dskip"],
        "B_x": _B_in["x"],
        "B_w1": _B_in["w1"],
        "B_w3": _B_in["w3"],
        "B_w2": _B_in["w2"],
        "gate_w": _w((lambda *s: torch.randn(*s, dtype=torch.bfloat16) * 0.05)(1024) * 16.0),
    }

def reference(A_x, A_Lambda_re, A_Lambda_im, A_B_re, A_B_im, A_C_re, A_C_im, A_log_dt, A_Dskip, B_x, B_w1, B_w3, B_w2, gate_w):
    def _A_ref(x, Lambda_re, Lambda_im, B_re, B_im, C_re, C_im, log_dt, Dskip):
        Bsz, L, H = x.shape
        Lam = Lambda_re + 1j * Lambda_im
        Bmat = B_re + 1j * B_im
        Cmat = C_re + 1j * C_im
        dt = torch.exp(log_dt)
        Lam_bar = torch.exp(dt * Lam)
        B_bar = ((Lam_bar - 1.0) / Lam)[:, None] * Bmat
        Bu = torch.einsum("bld,pd->blp", x + 0j, B_bar)
        h = torch.zeros_like(Bu[:, 0, :])
        hs = []
        for t in range(L):
            h = Lam_bar[None, :] * h + Bu[:, t, :]
            hs.append(h)
        hseq = torch.stack(hs, 1)
        y = 2.0 * torch.einsum("blp,dp->bld", hseq, Cmat).real + x * Dskip[None, None, :]
        return y

    def _B_ref(x, w1, w3, w2):
        gate = torch.einsum("bsd,df->bsf", x, w1)
        up = torch.einsum("bsd,df->bsf", x, w3)
        h = _silu(gate) * up
        out = torch.einsum("bsf,fd->bsd", h, w2)
        return out

    x = A_x
    g = _sigmoid((x * gate_w).sum(-1, keepdims=True))
    a = _A_ref(x, A_Lambda_re, A_Lambda_im, A_B_re, A_B_im, A_C_re, A_C_im, A_log_dt, A_Dskip)
    b = _B_ref(x, B_w1, B_w3, B_w2)
    return g * a + (1 - g) * b
```

```asm
; @launch kernel=k1_kernel grid=(256,1,1) block=(512,1,1) lds=158208
; @launch kernel=k3_kernel grid=(256,1,1) block=(256,1,1) lds=131072
.amdgcn_target "amdgcn-amd-amdhsa--gfx950"
.text
.globl k1_kernel
.p2align 8
.type k1_kernel,@function
k1_kernel:
  s_cmp_ge_u32 s2, 256
  s_cbranch_scc1 K1_done
  s_load_dwordx16 s[64:79], s[0:1], 0
  s_load_dwordx16 s[80:95], s[0:1], 64
  s_load_dwordx2 s[96:97], s[0:1], 128
  v_lshrrev_b32 v1, 6, v0
  s_nop 0
  v_readfirstlane_b32 s43, v1
  s_and_b32 s45, s2, 7
  s_lshl_b32 s45, s45, 2
  s_lshr_b32 s3, s2, 3
  s_and_b32 s3, s3, 3
  s_add_u32 s45, s45, s3
  s_lshr_b32 s44, s2, 5
  s_and_b32 s52, s43, 3
  s_lshr_b32 s53, s43, 2
  v_and_b32 v1, 63, v0
  s_waitcnt lgkmcnt(0)
  s_mov_b32 s8, s64
  s_and_b32 s9, s65, 0xffff
  s_mov_b32 s10, 0x400000
  s_mov_b32 s11, 0x00020000
  s_mov_b32 s24, s96
  s_and_b32 s25, s97, 0xffff
  s_mov_b32 s26, 0x10000000
  s_mov_b32 s27, 0x00020000
  s_cmp_eq_u32 s53, 0
  s_cselect_b32 s12, s70, s72
  s_cselect_b32 s13, s71, s73
  s_mov_b32 s14, 0x200000
  s_mov_b32 s15, 0x00020000
  s_cselect_b32 s16, s84, s86
  s_cselect_b32 s17, s85, s87
  s_mov_b32 s18, 0x700000
  s_mov_b32 s19, 0x00020000
  s_and_b32 s13, s13, 0xffff
  s_and_b32 s17, s17, 0xffff
  v_lshrrev_b32 v25, 3, v1
  v_and_b32 v24, 7, v1
  v_xor_b32 v24, v24, v25
  v_lshlrev_b32 v24, 4, v24
  v_lshlrev_b32 v25, 11, v25
  v_add_u32 v24, v24, v25
  s_lshl_b32 s3, s44, 8
  s_lshl_b32 s4, s43, 5
  s_add_u32 s3, s3, s4
  s_lshl_b32 s3, s3, 11
  s_add_u32 s4, s3, 0x0
  v_add_u32 v2, s4, v24
  s_add_u32 s4, s3, 0x3c00
  v_add_u32 v3, s4, v24
  s_add_u32 s4, s3, 0x7800
  v_add_u32 v4, s4, v24
  s_add_u32 s4, s3, 0xb400
  v_add_u32 v5, s4, v24
  s_lshl_b32 s3, s45, 5
  s_lshl_b32 s4, s52, 3
  s_add_u32 s3, s3, s4
  s_lshl_b32 s3, s3, 11
  v_add_u32 v6, s3, v24
  v_mul_u32_u24 v24, 37, v1
  v_lshrrev_b32 v24, 9, v24
  v_mul_u32_u24 v25, 14, v24
  v_sub_u32 v25, v1, v25
  v_lshlrev_b32 v25, 4, v25
  s_movk_i32 s4, 0x1c00
  v_mul_lo_u32 v24, s4, v24
  v_add_u32 v24, v24, v25
  s_mul_i32 s3, s45, 224
  s_lshl_b32 s5, s52, 1
  s_add_u32 s5, s5, 0
  s_and_b32 s5, s5, 3
  s_lshl_b32 s5, s5, 3
  s_lshr_b32 s6, s52, 1
  s_lshl_b32 s6, s6, 2
  s_add_u32 s5, s5, s6
  s_mul_i32 s5, s5, 7168
  s_add_u32 s5, s5, s3
  s_sub_u32 s5, s5, 0
  v_add_u32 v7, s5, v24
  s_lshl_b32 s5, s52, 1
  s_add_u32 s5, s5, 1
  s_and_b32 s5, s5, 3
  s_lshl_b32 s5, s5, 3
  s_lshr_b32 s6, s52, 1
  s_lshl_b32 s6, s6, 2
  s_add_u32 s5, s5, s6
  s_mul_i32 s5, s5, 7168
  s_add_u32 s5, s5, s3
  s_sub_u32 s5, s5, 896
  v_add_u32 v8, s5, v24
  s_mov_b32 s46, -1
  s_mov_b32 s47, 0x00ffffff
  s_lshl_b32 s48, s43, 12
  s_lshl_b32 s49, s43, 10
  s_add_u32 s49, s49, 98304
  s_mul_i32 s50, s52, 1792
  s_mul_i32 s3, s53, 7168
  s_add_u32 s50, s50, s3
  s_add_u32 s50, s50, 114688
  s_mov_b32 s40, 0
  s_mov_b32 s41, 0
  s_mov_b32 s61, 0
  s_mov_b32 s63, 0
  s_mov_b32 s60, 0
  s_mov_b32 s62, 0
  s_mov_b32 s54, 0
  s_mov_b32 s55, 0
  s_add_u32 m0, s48, s61
  s_nop 0
  buffer_load_dwordx4 v2, s[8:11], s40 offen offset:0 lds
  buffer_load_dwordx4 v3, s[8:11], s40 offen offset:1024 lds
  buffer_load_dwordx4 v4, s[8:11], s40 offen offset:2048 lds
  buffer_load_dwordx4 v5, s[8:11], s40 offen offset:3072 lds
  s_add_u32 s40, s40, 128
  s_add_u32 s61, s61, 32768
  s_cmp_ge_u32 s61, 98304
  s_cselect_b32 s61, 0, s61
  s_mov_b32 s3, 0
  s_add_u32 m0, s49, s3
  s_nop 0
  buffer_load_dwordx4 v6, s[12:15], s55 offen lds
  s_add_u32 s55, s55, 128
  s_add_u32 m0, s50, s63
  s_mov_b64 exec, s[46:47]
  buffer_load_dwordx4 v7, s[16:19], s41 offen offset:0 lds
  s_mov_b64 exec, -1
  s_mov_b64 exec, s[46:47]
  buffer_load_dwordx4 v8, s[16:19], s41 offen offset:896 lds
  s_mov_b64 exec, -1
  s_add_u32 s41, s41, 0x38000
  s_add_u32 s63, s63, 14336
  s_cmp_ge_u32 s63, 43008
  s_cselect_b32 s63, 0, s63
  s_add_u32 m0, s50, s63
  s_mov_b64 exec, s[46:47]
  buffer_load_dwordx4 v7, s[16:19], s41 offen offset:0 lds
  s_mov_b64 exec, -1
  s_mov_b64 exec, s[46:47]
  buffer_load_dwordx4 v8, s[16:19], s41 offen offset:896 lds
  s_mov_b64 exec, -1
  s_add_u32 s41, s41, 0x38000
  s_add_u32 s63, s63, 14336
  s_cmp_ge_u32 s63, 43008
  s_cselect_b32 s63, 0, s63
  s_lshl_b32 s3, s45, 5
  v_and_b32 v24, 31, v1
  v_add_u32 v24, s3, v24
  v_lshlrev_b32 v24, 1, v24
  s_mov_b32 s28, s66
  s_and_b32 s29, s67, 0xffff
  s_mov_b32 s30, 0x800
  s_mov_b32 s31, 0x00020000
  buffer_load_ushort v80, v24, s[28:31], 0 offen
  s_mov_b32 s32, s68
  s_and_b32 s33, s69, 0xffff
  s_mov_b32 s34, 0x800
  s_mov_b32 s35, 0x00020000
  buffer_load_ushort v81, v24, s[32:35], 0 offen
  s_mov_b32 s36, s78
  s_and_b32 s37, s79, 0xffff
  s_mov_b32 s38, 0x800
  s_mov_b32 s39, 0x00020000
  buffer_load_ushort v82, v24, s[36:39], 0 offen
  s_mov_b32 s56, s90
  s_and_b32 s57, s91, 0xffff
  s_mov_b32 s58, 0x800
  s_mov_b32 s59, 0x00020000
  v_lshlrev_b32 v24, 4, v1
  buffer_load_dwordx4 v[48:51], v24, s[56:59], 0 offen
  buffer_load_dwordx4 v[52:55], v24, s[56:59], 0 offen offset:1024
  s_lshl_b32 s3, s44, 8
  s_lshl_b32 s4, s45, 3
  s_add_u32 s3, s3, s4
  s_add_u32 s51, s3, s43
  s_lshl_b32 s3, s51, 11
  v_add_u32 v25, s3, v24
  buffer_load_dwordx4 v[40:43], v25, s[8:11], 0 offen offset:0
  buffer_load_dwordx4 v[44:47], v25, s[8:11], 0 offen offset:1024
  s_add_u32 m0, s48, s61
  s_nop 0
  buffer_load_dwordx4 v2, s[8:11], s40 offen offset:0 lds
  buffer_load_dwordx4 v3, s[8:11], s40 offen offset:1024 lds
  buffer_load_dwordx4 v4, s[8:11], s40 offen offset:2048 lds
  buffer_load_dwordx4 v5, s[8:11], s40 offen offset:3072 lds
  s_add_u32 s40, s40, 128
  s_add_u32 s61, s61, 32768
  s_cmp_ge_u32 s61, 98304
  s_cselect_b32 s61, 0, s61
  s_movk_i32 s3, 0x2000
  s_add_u32 m0, s49, s3
  s_nop 0
  buffer_load_dwordx4 v6, s[12:15], s55 offen lds
  s_add_u32 s55, s55, 128
  s_add_u32 m0, s50, s63
  s_mov_b64 exec, s[46:47]
  buffer_load_dwordx4 v7, s[16:19], s41 offen offset:0 lds
  s_mov_b64 exec, -1
  s_mov_b64 exec, s[46:47]
  buffer_load_dwordx4 v8, s[16:19], s41 offen offset:896 lds
  s_mov_b64 exec, -1
  s_add_u32 s41, s41, 0x38000
  s_add_u32 s63, s63, 14336
  s_cmp_ge_u32 s63, 43008
  s_cselect_b32 s63, 0, s63
  s_mov_b32 s28, s88
  s_and_b32 s29, s89, 0xffff
  s_mov_b32 s30, 0x700000
  s_mov_b32 s31, 0x00020000
  s_mov_b32 s32, s74
  s_and_b32 s33, s75, 0xffff
  s_mov_b32 s34, 0x200000
  s_mov_b32 s35, 0x00020000
  s_mov_b32 s36, s76
  s_and_b32 s37, s77, 0xffff
  s_mov_b32 s38, 0x200000
  s_mov_b32 s39, 0x00020000
  s_lshl_b32 s3, s2, 3
  s_add_u32 s3, s3, s43
  s_mul_i32 s4, s3, 28
  v_add_u32 v24, s4, v1
  v_lshlrev_b32 v24, 7, v24
  v_cmp_gt_u32 vcc, 28, v1
  v_mov_b32 v25, -1
  s_nop 0
  v_cndmask_b32 v24, v25, v24, vcc
  buffer_load_dword v32, v24, s[28:31], 0 offen
  s_lshl_b32 s4, s3, 3
  v_and_b32 v24, 7, v1
  v_add_u32 v24, s4, v24
  v_lshlrev_b32 v24, 7, v24
  buffer_load_dword v33, v24, s[32:35], 0 offen
  buffer_load_dword v34, v24, s[36:39], 0 offen
  v_lshrrev_b32 v24, 4, v1
  v_and_b32 v25, 7, v1
  v_xor_b32 v24, v24, v25
  v_lshlrev_b32 v24, 4, v24
  v_and_b32 v25, 15, v1
  v_lshlrev_b32 v25, 7, v25
  v_add_u32 v24, v24, v25
  v_xor_b32 v25, 64, v24
  v_mov_b32 v11, v24
  v_mov_b32 v12, v25
  v_lshrrev_b32 v24, 4, v1
  v_lshlrev_b32 v24, 2, v24
  v_and_b32 v25, 15, v1
  v_lshrrev_b32 v25, 2, v25
  v_add_u32 v24, v24, v25
  v_mul_u32_u24 v24, 0xe0, v24
  v_and_b32 v25, 3, v1
  v_lshlrev_b32 v25, 3, v25
  v_add_u32 v24, v24, v25
  v_add_u32 v13, 0x1c000, v24
  v_accvgpr_write_b32 a0, 0
  v_accvgpr_write_b32 a1, 0
  v_accvgpr_write_b32 a2, 0
  v_accvgpr_write_b32 a3, 0
  v_accvgpr_write_b32 a4, 0
  v_accvgpr_write_b32 a5, 0
  v_accvgpr_write_b32 a6, 0
  v_accvgpr_write_b32 a7, 0
  v_accvgpr_write_b32 a8, 0
  v_accvgpr_write_b32 a9, 0
  v_accvgpr_write_b32 a10, 0
  v_accvgpr_write_b32 a11, 0
  v_accvgpr_write_b32 a12, 0
  v_accvgpr_write_b32 a13, 0
  v_accvgpr_write_b32 a14, 0
  v_accvgpr_write_b32 a15, 0
  v_accvgpr_write_b32 a16, 0
  v_accvgpr_write_b32 a17, 0
  v_accvgpr_write_b32 a18, 0
  v_accvgpr_write_b32 a19, 0
  v_accvgpr_write_b32 a20, 0
  v_accvgpr_write_b32 a21, 0
  v_accvgpr_write_b32 a22, 0
  v_accvgpr_write_b32 a23, 0
  v_accvgpr_write_b32 a24, 0
  v_accvgpr_write_b32 a25, 0
  v_accvgpr_write_b32 a26, 0
  v_accvgpr_write_b32 a27, 0
  v_accvgpr_write_b32 a28, 0
  v_accvgpr_write_b32 a29, 0
  v_accvgpr_write_b32 a30, 0
  v_accvgpr_write_b32 a31, 0
  v_accvgpr_write_b32 a32, 0
  v_accvgpr_write_b32 a33, 0
  v_accvgpr_write_b32 a34, 0
  v_accvgpr_write_b32 a35, 0
  v_accvgpr_write_b32 a36, 0
  v_accvgpr_write_b32 a37, 0
  v_accvgpr_write_b32 a38, 0
  v_accvgpr_write_b32 a39, 0
  v_accvgpr_write_b32 a40, 0
  v_accvgpr_write_b32 a41, 0
  v_accvgpr_write_b32 a42, 0
  v_accvgpr_write_b32 a43, 0
  v_accvgpr_write_b32 a44, 0
  v_accvgpr_write_b32 a45, 0
  v_accvgpr_write_b32 a46, 0
  v_accvgpr_write_b32 a47, 0
  v_accvgpr_write_b32 a48, 0
  v_accvgpr_write_b32 a49, 0
  v_accvgpr_write_b32 a50, 0
  v_accvgpr_write_b32 a51, 0
  v_accvgpr_write_b32 a52, 0
  v_accvgpr_write_b32 a53, 0
  v_accvgpr_write_b32 a54, 0
  v_accvgpr_write_b32 a55, 0
  v_accvgpr_write_b32 a56, 0
  v_accvgpr_write_b32 a57, 0
  v_accvgpr_write_b32 a58, 0
  v_accvgpr_write_b32 a59, 0
  v_accvgpr_write_b32 a60, 0
  v_accvgpr_write_b32 a61, 0
  v_accvgpr_write_b32 a62, 0
  v_accvgpr_write_b32 a63, 0
  v_accvgpr_write_b32 a64, 0
  v_accvgpr_write_b32 a65, 0
  v_accvgpr_write_b32 a66, 0
  v_accvgpr_write_b32 a67, 0
  v_accvgpr_write_b32 a68, 0
  v_accvgpr_write_b32 a69, 0
  v_accvgpr_write_b32 a70, 0
  v_accvgpr_write_b32 a71, 0
  v_accvgpr_write_b32 a72, 0
  v_accvgpr_write_b32 a73, 0
  v_accvgpr_write_b32 a74, 0
  v_accvgpr_write_b32 a75, 0
  v_accvgpr_write_b32 a76, 0
  v_accvgpr_write_b32 a77, 0
  v_accvgpr_write_b32 a78, 0
  v_accvgpr_write_b32 a79, 0
  v_accvgpr_write_b32 a80, 0
  v_accvgpr_write_b32 a81, 0
  v_accvgpr_write_b32 a82, 0
  v_accvgpr_write_b32 a83, 0
  v_accvgpr_write_b32 a84, 0
  v_accvgpr_write_b32 a85, 0
  v_accvgpr_write_b32 a86, 0
  v_accvgpr_write_b32 a87, 0
  v_accvgpr_write_b32 a88, 0
  v_accvgpr_write_b32 a89, 0
  v_accvgpr_write_b32 a90, 0
  v_accvgpr_write_b32 a91, 0
  v_accvgpr_write_b32 a92, 0
  v_accvgpr_write_b32 a93, 0
  v_accvgpr_write_b32 a94, 0
  v_accvgpr_write_b32 a95, 0
  v_accvgpr_write_b32 a96, 0
  v_accvgpr_write_b32 a97, 0
  v_accvgpr_write_b32 a98, 0
  v_accvgpr_write_b32 a99, 0
  v_accvgpr_write_b32 a100, 0
  v_accvgpr_write_b32 a101, 0
  v_accvgpr_write_b32 a102, 0
  v_accvgpr_write_b32 a103, 0
  v_accvgpr_write_b32 a104, 0
  v_accvgpr_write_b32 a105, 0
  v_accvgpr_write_b32 a106, 0
  v_accvgpr_write_b32 a107, 0
  v_accvgpr_write_b32 a108, 0
  v_accvgpr_write_b32 a109, 0
  v_accvgpr_write_b32 a110, 0
  v_accvgpr_write_b32 a111, 0
  v_accvgpr_write_b32 a112, 0
  v_accvgpr_write_b32 a113, 0
  v_accvgpr_write_b32 a114, 0
  v_accvgpr_write_b32 a115, 0
  v_accvgpr_write_b32 a116, 0
  v_accvgpr_write_b32 a117, 0
  v_accvgpr_write_b32 a118, 0
  v_accvgpr_write_b32 a119, 0
  v_accvgpr_write_b32 a120, 0
  v_accvgpr_write_b32 a121, 0
  v_accvgpr_write_b32 a122, 0
  v_accvgpr_write_b32 a123, 0
  v_accvgpr_write_b32 a124, 0
  v_accvgpr_write_b32 a125, 0
  v_accvgpr_write_b32 a126, 0
  v_accvgpr_write_b32 a127, 0
  v_mov_b32 v96, 0
  v_mov_b32 v97, 0
  v_mov_b32 v98, 0
  v_mov_b32 v99, 0
  v_mov_b32 v100, 0
  v_mov_b32 v101, 0
  v_mov_b32 v102, 0
  v_mov_b32 v103, 0
  v_mov_b32 v104, 0
  v_mov_b32 v105, 0
  v_mov_b32 v106, 0
  v_mov_b32 v107, 0
  v_mov_b32 v108, 0
  v_mov_b32 v109, 0
  v_mov_b32 v110, 0
  v_mov_b32 v111, 0
  v_mov_b32 v112, 0
  v_mov_b32 v113, 0
  v_mov_b32 v114, 0
  v_mov_b32 v115, 0
  v_mov_b32 v116, 0
  v_mov_b32 v117, 0
  v_mov_b32 v118, 0
  v_mov_b32 v119, 0
  v_mov_b32 v120, 0
  v_mov_b32 v121, 0
  v_mov_b32 v122, 0
  v_mov_b32 v123, 0
  v_mov_b32 v124, 0
  v_mov_b32 v125, 0
  v_mov_b32 v126, 0
  v_mov_b32 v127, 0
  s_waitcnt vmcnt(14)
  v_lshlrev_b32 v24, 16, v80
  v_lshlrev_b32 v25, 16, v81
  v_lshlrev_b32 v26, 16, v82
  v_mul_f32 v26, 0x3fb8aa3b, v26
  v_exp_f32 v26, v26
  s_nop 0
  v_cvt_pk_bf16_f32 v26, v26, v26
  v_lshlrev_b32 v26, 16, v26
  v_mul_f32 v27, v26, v24
  v_mul_f32 v28, v26, v25
  v_mul_f32 v27, 0x3fb8aa3b, v27
  v_exp_f32 v27, v27
  v_mul_f32 v28, 0x3e22f983, v28
  v_cos_f32 v29, v28
  v_sin_f32 v28, v28
  s_nop 0
  v_mul_f32 v84, v27, v29
  v_mul_f32 v85, v27, v28
  v_add_f32 v27, -1.0, v84
  v_mul_f32 v28, v24, v24
  v_fma_f32 v28, v25, v25, v28
  v_rcp_f32 v28, v28
  v_mul_f32 v29, v27, v24
  v_fma_f32 v29, v85, v25, v29
  v_mul_f32 v86, v29, v28
  v_mul_f32 v29, v85, v24
  v_fma_f32 v29, -v27, v25, v29
  v_mul_f32 v87, v29, v28
  v_lshlrev_b32 v24, 4, v0
  v_add_u32 v24, 0x26800, v24
  v_cmp_gt_u32 vcc, 32, v0
  s_and_saveexec_b64 s[4:5], vcc
  ds_write_b128 v24, v[84:87]
  s_mov_b64 exec, s[4:5]
  s_waitcnt vmcnt(10)
  v_mov_b32 v56, 0
  v_lshlrev_b32 v24, 16, v40
  v_lshlrev_b32 v25, 16, v48
  v_and_b32 v26, 0xffff0000, v40
  v_and_b32 v27, 0xffff0000, v48
  v_mul_f32 v24, v24, v25
  v_mul_f32 v26, v26, v27
  v_cvt_pk_bf16_f32 v24, v24, v26
  v_lshlrev_b32 v25, 16, v24
  v_and_b32 v26, 0xffff0000, v24
  v_add_f32 v56, v56, v25
  v_add_f32 v56, v56, v26
  v_lshlrev_b32 v24, 16, v41
  v_lshlrev_b32 v25, 16, v49
  v_and_b32 v26, 0xffff0000, v41
  v_and_b32 v27, 0xffff0000, v49
  v_mul_f32 v24, v24, v25
  v_mul_f32 v26, v26, v27
  v_cvt_pk_bf16_f32 v24, v24, v26
  v_lshlrev_b32 v25, 16, v24
  v_and_b32 v26, 0xffff0000, v24
  v_add_f32 v56, v56, v25
  v_add_f32 v56, v56, v26
  v_lshlrev_b32 v24, 16, v42
  v_lshlrev_b32 v25, 16, v50
  v_and_b32 v26, 0xffff0000, v42
  v_and_b32 v27, 0xffff0000, v50
  v_mul_f32 v24, v24, v25
  v_mul_f32 v26, v26, v27
  v_cvt_pk_bf16_f32 v24, v24, v26
  v_lshlrev_b32 v25, 16, v24
  v_and_b32 v26, 0xffff0000, v24
  v_add_f32 v56, v56, v25
  v_add_f32 v56, v56, v26
  v_lshlrev_b32 v24, 16, v43
  v_lshlrev_b32 v25, 16, v51
  v_and_b32 v26, 0xffff0000, v43
  v_and_b32 v27, 0xffff0000, v51
  v_mul_f32 v24, v24, v25
  v_mul_f32 v26, v26, v27
  v_cvt_pk_bf16_f32 v24, v24, v26
  v_lshlrev_b32 v25, 16, v24
  v_and_b32 v26, 0xffff0000, v24
  v_add_f32 v56, v56, v25
  v_add_f32 v56, v56, v26
  v_lshlrev_b32 v24, 16, v44
  v_lshlrev_b32 v25, 16, v52
  v_and_b32 v26, 0xffff0000, v44
  v_and_b32 v27, 0xffff0000, v52
  v_mul_f32 v24, v24, v25
  v_mul_f32 v26, v26, v27
  v_cvt_pk_bf16_f32 v24, v24, v26
  v_lshlrev_b32 v25, 16, v24
  v_and_b32 v26, 0xffff0000, v24
  v_add_f32 v56, v56, v25
  v_add_f32 v56, v56, v26
  v_lshlrev_b32 v24, 16, v45
  v_lshlrev_b32 v25, 16, v53
  v_and_b32 v26, 0xffff0000, v45
  v_and_b32 v27, 0xffff0000, v53
  v_mul_f32 v24, v24, v25
  v_mul_f32 v26, v26, v27
  v_cvt_pk_bf16_f32 v24, v24, v26
  v_lshlrev_b32 v25, 16, v24
  v_and_b32 v26, 0xffff0000, v24
  v_add_f32 v56, v56, v25
  v_add_f32 v56, v56, v26
  v_lshlrev_b32 v24, 16, v46
  v_lshlrev_b32 v25, 16, v54
  v_and_b32 v26, 0xffff0000, v46
  v_and_b32 v27, 0xffff0000, v54
  v_mul_f32 v24, v24, v25
  v_mul_f32 v26, v26, v27
  v_cvt_pk_bf16_f32 v24, v24, v26
  v_lshlrev_b32 v25, 16, v24
  v_and_b32 v26, 0xffff0000, v24
  v_add_f32 v56, v56, v25
  v_add_f32 v56, v56, v26
  v_lshlrev_b32 v24, 16, v47
  v_lshlrev_b32 v25, 16, v55
  v_and_b32 v26, 0xffff0000, v47
  v_and_b32 v27, 0xffff0000, v55
  v_mul_f32 v24, v24, v25
  v_mul_f32 v26, v26, v27
  v_cvt_pk_bf16_f32 v24, v24, v26
  v_lshlrev_b32 v25, 16, v24
  v_and_b32 v26, 0xffff0000, v24
  v_add_f32 v56, v56, v25
  v_add_f32 v56, v56, v26
  v_xor_b32 v24, 1, v1
  v_lshlrev_b32 v24, 2, v24
  ds_bpermute_b32 v25, v24, v56
  s_waitcnt lgkmcnt(0)
  v_add_f32 v56, v56, v25
  v_xor_b32 v24, 2, v1
  v_lshlrev_b32 v24, 2, v24
  ds_bpermute_b32 v25, v24, v56
  s_waitcnt lgkmcnt(0)
  v_add_f32 v56, v56, v25
  v_xor_b32 v24, 4, v1
  v_lshlrev_b32 v24, 2, v24
  ds_bpermute_b32 v25, v24, v56
  s_waitcnt lgkmcnt(0)
  v_add_f32 v56, v56, v25
  v_xor_b32 v24, 8, v1
  v_lshlrev_b32 v24, 2, v24
  ds_bpermute_b32 v25, v24, v56
  s_waitcnt lgkmcnt(0)
  v_add_f32 v56, v56, v25
  v_xor_b32 v24, 16, v1
  v_lshlrev_b32 v24, 2, v24
  ds_bpermute_b32 v25, v24, v56
  s_waitcnt lgkmcnt(0)
  v_add_f32 v56, v56, v25
  v_xor_b32 v24, 32, v1
  v_lshlrev_b32 v24, 2, v24
  ds_bpermute_b32 v25, v24, v56
  s_waitcnt lgkmcnt(0)
  v_add_f32 v56, v56, v25
  v_cvt_pk_bf16_f32 v56, v56, v56
  v_lshlrev_b32 v56, 16, v56
  v_mul_f32 v56, 0xbfb8aa3b, v56
  v_exp_f32 v56, v56
  s_nop 0
  v_add_f32 v56, 1.0, v56
  v_rcp_f32 v56, v56
  s_nop 0
  v_cvt_pk_bf16_f32 v56, v56, v56
  v_lshlrev_b32 v56, 16, v56
  s_lshl_b32 s3, s51, 2
  s_add_u32 s3, s3, 0x2900000
  v_mov_b32 v24, s3
  v_cmp_eq_u32 vcc, 0, v1
  s_and_saveexec_b64 s[4:5], vcc
  buffer_store_dword v56, v24, s[24:27], 0 offen
  s_mov_b64 exec, s[4:5]
  s_barrier
  s_mov_b32 s42, 0
  s_cmp_eq_u32 s53, 0
  s_cbranch_scc0 K1_main1
  s_lshl_b32 s3, s52, 13
  s_add_u32 s3, s3, s60
  v_add_u32 v16, s3, v11
  s_add_u32 s3, s54, 98304
  v_add_u32 v19, s3, v11
  v_add_u32 v21, s62, v13
  ds_read_b128 v[40:43], v16 offset:0
  ds_read_b128 v[44:47], v16 offset:2048
  ds_read_b128 v[72:75], v19 offset:0
  ds_read_b128 v[48:51], v16 offset:4096
  ds_read_b128 v[76:79], v19 offset:2048
  ds_read_b128 v[52:55], v16 offset:6144
  ds_read_b128 v[80:83], v19 offset:4096
K1_loop0:
  v_mov_b32 v14, v16
  s_lshl_b32 s3, s52, 13
  s_add_u32 s3, s3, s60
  v_add_u32 v15, s3, v12
  v_mov_b32 v17, v19
  s_add_u32 s3, s54, 98304
  v_add_u32 v18, s3, v12
  v_mov_b32 v20, v21
  s_add_u32 s60, s60, 32768
  s_cmp_ge_u32 s60, 98304
  s_cselect_b32 s60, 0, s60
  s_xor_b32 s54, s54, 0x2000
  s_add_u32 s62, s62, 14336
  s_cmp_ge_u32 s62, 43008
  s_cselect_b32 s62, 0, s62
  ds_read_b128 v[84:87], v17 offset:6144
  s_waitcnt lgkmcnt(2)
  v_mfma_f32_16x16x32_bf16 a[0:3], v[40:43], v[72:75], a[0:3]
  v_mfma_f32_16x16x32_bf16 a[4:7], v[44:47], v[72:75], a[4:7]
  v_mfma_f32_16x16x32_bf16 a[8:11], v[48:51], v[72:75], a[8:11]
  v_mfma_f32_16x16x32_bf16 a[12:15], v[52:55], v[72:75], a[12:15]
  s_add_u32 m0, s48, s61
  s_nop 0
  buffer_load_dwordx4 v2, s[8:11], s40 offen offset:0 lds
  ds_read_b64_tr_b16 v[72:73], v20 offset:0
  ds_read_b64_tr_b16 v[74:75], v20 offset:3584
  v_mfma_f32_16x16x32_bf16 a[16:19], v[40:43], v[76:79], a[16:19]
  v_mfma_f32_16x16x32_bf16 a[20:23], v[44:47], v[76:79], a[20:23]
  v_mfma_f32_16x16x32_bf16 a[24:27], v[48:51], v[76:79], a[24:27]
  v_mfma_f32_16x16x32_bf16 a[28:31], v[52:55], v[76:79], a[28:31]
  buffer_load_dwordx4 v3, s[8:11], s40 offen offset:1024 lds
  ds_read_b64_tr_b16 v[76:77], v20 offset:32
  ds_read_b64_tr_b16 v[78:79], v20 offset:3616
  s_waitcnt lgkmcnt(5)
  v_mfma_f32_16x16x32_bf16 a[32:35], v[40:43], v[80:83], a[32:35]
  v_mfma_f32_16x16x32_bf16 a[36:39], v[44:47], v[80:83], a[36:39]
  v_mfma_f32_16x16x32_bf16 a[40:43], v[48:51], v[80:83], a[40:43]
  v_mfma_f32_16x16x32_bf16 a[44:47], v[52:55], v[80:83], a[44:47]
  buffer_load_dwordx4 v4, s[8:11], s40 offen offset:2048 lds
  ds_read_b64_tr_b16 v[80:81], v20 offset:7168
  ds_read_b64_tr_b16 v[82:83], v20 offset:10752
  s_waitcnt lgkmcnt(6)
  v_mfma_f32_16x16x32_bf16 a[48:51], v[40:43], v[84:87], a[48:51]
  v_mfma_f32_16x16x32_bf16 a[52:55], v[44:47], v[84:87], a[52:55]
  v_mfma_f32_16x16x32_bf16 a[56:59], v[48:51], v[84:87], a[56:59]
  v_mfma_f32_16x16x32_bf16 a[60:63], v[52:55], v[84:87], a[60:63]
  buffer_load_dwordx4 v5, s[8:11], s40 offen offset:3072 lds
  s_add_u32 s40, s40, 128
  s_add_u32 s61, s61, 32768
  s_cmp_ge_u32 s61, 98304
  s_cselect_b32 s61, 0, s61
  ds_read_b64_tr_b16 v[84:85], v20 offset:7200
  ds_read_b64_tr_b16 v[86:87], v20 offset:10784
  ds_read_b128 v[56:59], v15 offset:0
  s_waitcnt lgkmcnt(7)
  v_mfma_f32_16x16x32_bf16 a[64:67], v[72:75], v[40:43], a[64:67]
  v_mfma_f32_16x16x32_bf16 a[68:71], v[72:75], v[44:47], a[68:71]
  v_mfma_f32_16x16x32_bf16 a[72:75], v[72:75], v[48:51], a[72:75]
  v_mfma_f32_16x16x32_bf16 a[76:79], v[72:75], v[52:55], a[76:79]
  s_waitcnt lgkmcnt(0)
  s_waitcnt vmcnt(7)
  s_barrier
  v_add_u32 v21, s62, v13
  s_add_u32 s62, s62, 14336
  s_cmp_ge_u32 s62, 43008
  s_cselect_b32 s62, 0, s62
  s_add_u32 m0, s50, s63
  s_mov_b64 exec, s[46:47]
  buffer_load_dwordx4 v7, s[16:19], s41 offen offset:0 lds
  s_mov_b64 exec, -1
  s_mov_b64 exec, s[46:47]
  buffer_load_dwordx4 v8, s[16:19], s41 offen offset:896 lds
  s_mov_b64 exec, -1
  s_add_u32 s41, s41, 0x38000
  s_add_u32 s63, s63, 14336
  s_cmp_ge_u32 s63, 43008
  s_cselect_b32 s63, 0, s63
  ds_read_b128 v[72:75], v18 offset:0
  ds_read_b128 v[60:63], v15 offset:2048
  v_mfma_f32_16x16x32_bf16 a[80:83], v[76:79], v[40:43], a[80:83]
  v_mfma_f32_16x16x32_bf16 a[84:87], v[76:79], v[44:47], a[84:87]
  v_mfma_f32_16x16x32_bf16 a[88:91], v[76:79], v[48:51], a[88:91]
  v_mfma_f32_16x16x32_bf16 a[92:95], v[76:79], v[52:55], a[92:95]
  ds_read_b128 v[76:79], v18 offset:2048
  ds_read_b128 v[64:67], v15 offset:4096
  v_mfma_f32_16x16x32_bf16 a[96:99], v[80:83], v[40:43], a[96:99]
  v_mfma_f32_16x16x32_bf16 a[100:103], v[80:83], v[44:47], a[100:103]
  v_mfma_f32_16x16x32_bf16 a[104:107], v[80:83], v[48:51], a[104:107]
  v_mfma_f32_16x16x32_bf16 a[108:111], v[80:83], v[52:55], a[108:111]
  ds_read_b128 v[80:83], v18 offset:4096
  ds_read_b128 v[68:71], v15 offset:6144
  v_mfma_f32_16x16x32_bf16 a[112:115], v[84:87], v[40:43], a[112:115]
  v_mfma_f32_16x16x32_bf16 a[116:119], v[84:87], v[44:47], a[116:119]
  v_mfma_f32_16x16x32_bf16 a[120:123], v[84:87], v[48:51], a[120:123]
  v_mfma_f32_16x16x32_bf16 a[124:127], v[84:87], v[52:55], a[124:127]
  ds_read_b128 v[84:87], v18 offset:6144
  s_waitcnt lgkmcnt(1)
  v_mfma_f32_16x16x32_bf16 a[0:3], v[56:59], v[72:75], a[0:3]
  v_mfma_f32_16x16x32_bf16 a[4:7], v[60:63], v[72:75], a[4:7]
  v_mfma_f32_16x16x32_bf16 a[8:11], v[64:67], v[72:75], a[8:11]
  v_mfma_f32_16x16x32_bf16 a[12:15], v[68:71], v[72:75], a[12:15]
  ds_read_b64_tr_b16 v[72:73], v21 offset:0
  ds_read_b64_tr_b16 v[74:75], v21 offset:3584
  v_mfma_f32_16x16x32_bf16 a[16:19], v[56:59], v[76:79], a[16:19]
  v_mfma_f32_16x16x32_bf16 a[20:23], v[60:63], v[76:79], a[20:23]
  v_mfma_f32_16x16x32_bf16 a[24:27], v[64:67], v[76:79], a[24:27]
  v_mfma_f32_16x16x32_bf16 a[28:31], v[68:71], v[76:79], a[28:31]
  ds_read_b64_tr_b16 v[76:77], v21 offset:32
  ds_read_b64_tr_b16 v[78:79], v21 offset:3616
  v_mfma_f32_16x16x32_bf16 a[32:35], v[56:59], v[80:83], a[32:35]
  v_mfma_f32_16x16x32_bf16 a[36:39], v[60:63], v[80:83], a[36:39]
  v_mfma_f32_16x16x32_bf16 a[40:43], v[64:67], v[80:83], a[40:43]
  v_mfma_f32_16x16x32_bf16 a[44:47], v[68:71], v[80:83], a[44:47]
  ds_read_b64_tr_b16 v[80:81], v21 offset:7168
  ds_read_b64_tr_b16 v[82:83], v21 offset:10752
  s_waitcnt lgkmcnt(6)
  v_mfma_f32_16x16x32_bf16 a[48:51], v[56:59], v[84:87], a[48:51]
  v_mfma_f32_16x16x32_bf16 a[52:55], v[60:63], v[84:87], a[52:55]
  v_mfma_f32_16x16x32_bf16 a[56:59], v[64:67], v[84:87], a[56:59]
  v_mfma_f32_16x16x32_bf16 a[60:63], v[68:71], v[84:87], a[60:63]
  ds_read_b64_tr_b16 v[84:85], v21 offset:7200
  ds_read_b64_tr_b16 v[86:87], v21 offset:10784
  s_waitcnt lgkmcnt(6)
  v_mfma_f32_16x16x32_bf16 a[64:67], v[72:75], v[56:59], a[64:67]
  v_mfma_f32_16x16x32_bf16 a[68:71], v[72:75], v[60:63], a[68:71]
  v_mfma_f32_16x16x32_bf16 a[72:75], v[72:75], v[64:67], a[72:75]
  v_mfma_f32_16x16x32_bf16 a[76:79], v[72:75], v[68:71], a[76:79]
  s_waitcnt lgkmcnt(0)
  s_waitcnt vmcnt(6)
  s_barrier
  s_lshl_b32 s3, s52, 13
  s_add_u32 s3, s3, s60
  v_add_u32 v16, s3, v11
  s_add_u32 s3, s54, 98304
  v_add_u32 v19, s3, v11
  s_xor_b32 s3, s54, 0x2000
  s_add_u32 m0, s49, s3
  s_nop 0
  buffer_load_dwordx4 v6, s[12:15], s55 offen lds
  s_add_u32 s55, s55, 128
  s_add_u32 m0, s50, s63
  s_mov_b64 exec, s[46:47]
  buffer_load_dwordx4 v7, s[16:19], s41 offen offset:0 lds
  s_mov_b64 exec, -1
  s_mov_b64 exec, s[46:47]
  buffer_load_dwordx4 v8, s[16:19], s41 offen offset:896 lds
  s_mov_b64 exec, -1
  s_add_u32 s41, s41, 0x38000
  s_add_u32 s63, s63, 14336
  s_cmp_ge_u32 s63, 43008
  s_cselect_b32 s63, 0, s63
  v_add_u32 v21, s62, v13
  ds_read_b128 v[40:43], v16 offset:0
  ds_read_b128 v[44:47], v16 offset:2048
  ds_read_b128 v[72:75], v19 offset:0
  v_mfma_f32_16x16x32_bf16 a[80:83], v[76:79], v[56:59], a[80:83]
  v_mfma_f32_16x16x32_bf16 a[84:87], v[76:79], v[60:63], a[84:87]
  v_mfma_f32_16x16x32_bf16 a[88:91], v[76:79], v[64:67], a[88:91]
  v_mfma_f32_16x16x32_bf16 a[92:95], v[76:79], v[68:71], a[92:95]
  ds_read_b128 v[48:51], v16 offset:4096
  ds_read_b128 v[76:79], v19 offset:2048
  v_mfma_f32_16x16x32_bf16 a[96:99], v[80:83], v[56:59], a[96:99]
  v_mfma_f32_16x16x32_bf16 a[100:103], v[80:83], v[60:63], a[100:103]
  v_mfma_f32_16x16x32_bf16 a[104:107], v[80:83], v[64:67], a[104:107]
  v_mfma_f32_16x16x32_bf16 a[108:111], v[80:83], v[68:71], a[108:111]
  ds_read_b128 v[52:55], v16 offset:6144
  ds_read_b128 v[80:83], v19 offset:4096
  v_mfma_f32_16x16x32_bf16 a[112:115], v[84:87], v[56:59], a[112:115]
  v_mfma_f32_16x16x32_bf16 a[116:119], v[84:87], v[60:63], a[116:119]
  v_mfma_f32_16x16x32_bf16 a[120:123], v[84:87], v[64:67], a[120:123]
  v_mfma_f32_16x16x32_bf16 a[124:127], v[84:87], v[68:71], a[124:127]
  s_add_u32 s42, s42, 1
  s_cmp_lt_u32 s42, 16
  s_cbranch_scc1 K1_loop0
  s_branch K1_main_end
K1_main1:
  s_lshl_b32 s3, s52, 13
  s_add_u32 s3, s3, s60
  v_add_u32 v16, s3, v11
  s_add_u32 s3, s54, 98304
  v_add_u32 v19, s3, v11
  v_add_u32 v21, s62, v13
  ds_read_b128 v[40:43], v16 offset:0
  ds_read_b128 v[44:47], v16 offset:2048
  ds_read_b64_tr_b16 v[72:73], v21 offset:64
  ds_read_b64_tr_b16 v[74:75], v21 offset:3648
  ds_read_b128 v[48:51], v16 offset:4096
  ds_read_b64_tr_b16 v[76:77], v21 offset:96
  ds_read_b64_tr_b16 v[78:79], v21 offset:3680
  ds_read_b128 v[52:55], v16 offset:6144
  ds_read_b64_tr_b16 v[80:81], v21 offset:128
  ds_read_b64_tr_b16 v[82:83], v21 offset:3712
K1_loop1:
  v_mov_b32 v14, v16
  s_lshl_b32 s3, s52, 13
  s_add_u32 s3, s3, s60
  v_add_u32 v15, s3, v12
  v_mov_b32 v17, v19
  s_add_u32 s3, s54, 98304
  v_add_u32 v18, s3, v12
  v_mov_b32 v20, v21
  s_add_u32 s60, s60, 32768
  s_cmp_ge_u32 s60, 98304
  s_cselect_b32 s60, 0, s60
  s_xor_b32 s54, s54, 0x2000
  s_add_u32 s62, s62, 14336
  s_cmp_ge_u32 s62, 43008
  s_cselect_b32 s62, 0, s62
  ds_read_b64_tr_b16 v[84:85], v20 offset:160
  ds_read_b64_tr_b16 v[86:87], v20 offset:3744
  s_waitcnt lgkmcnt(4)
  v_mfma_f32_16x16x32_bf16 a[0:3], v[72:75], v[40:43], a[0:3]
  v_mfma_f32_16x16x32_bf16 a[4:7], v[72:75], v[44:47], a[4:7]
  v_mfma_f32_16x16x32_bf16 a[8:11], v[72:75], v[48:51], a[8:11]
  v_mfma_f32_16x16x32_bf16 a[12:15], v[72:75], v[52:55], a[12:15]
  s_add_u32 m0, s48, s61
  s_nop 0
  buffer_load_dwordx4 v2, s[8:11], s40 offen offset:0 lds
  ds_read_b64_tr_b16 v[72:73], v20 offset:192
  ds_read_b64_tr_b16 v[74:75], v20 offset:3776
  v_mfma_f32_16x16x32_bf16 a[16:19], v[76:79], v[40:43], a[16:19]
  v_mfma_f32_16x16x32_bf16 a[20:23], v[76:79], v[44:47], a[20:23]
  v_mfma_f32_16x16x32_bf16 a[24:27], v[76:79], v[48:51], a[24:27]
  v_mfma_f32_16x16x32_bf16 a[28:31], v[76:79], v[52:55], a[28:31]
  buffer_load_dwordx4 v3, s[8:11], s40 offen offset:1024 lds
  ds_read_b64_tr_b16 v[76:77], v20 offset:7232
  ds_read_b64_tr_b16 v[78:79], v20 offset:10816
  s_waitcnt lgkmcnt(6)
  v_mfma_f32_16x16x32_bf16 a[32:35], v[80:83], v[40:43], a[32:35]
  v_mfma_f32_16x16x32_bf16 a[36:39], v[80:83], v[44:47], a[36:39]
  v_mfma_f32_16x16x32_bf16 a[40:43], v[80:83], v[48:51], a[40:43]
  v_mfma_f32_16x16x32_bf16 a[44:47], v[80:83], v[52:55], a[44:47]
  buffer_load_dwordx4 v4, s[8:11], s40 offen offset:2048 lds
  ds_read_b64_tr_b16 v[80:81], v20 offset:7264
  ds_read_b64_tr_b16 v[82:83], v20 offset:10848
  s_waitcnt lgkmcnt(6)
  v_mfma_f32_16x16x32_bf16 a[48:51], v[84:87], v[40:43], a[48:51]
  v_mfma_f32_16x16x32_bf16 a[52:55], v[84:87], v[44:47], a[52:55]
  v_mfma_f32_16x16x32_bf16 a[56:59], v[84:87], v[48:51], a[56:59]
  v_mfma_f32_16x16x32_bf16 a[60:63], v[84:87], v[52:55], a[60:63]
  buffer_load_dwordx4 v5, s[8:11], s40 offen offset:3072 lds
  s_add_u32 s40, s40, 128
  s_add_u32 s61, s61, 32768
  s_cmp_ge_u32 s61, 98304
  s_cselect_b32 s61, 0, s61
  ds_read_b64_tr_b16 v[84:85], v20 offset:7296
  ds_read_b64_tr_b16 v[86:87], v20 offset:10880
  s_waitcnt lgkmcnt(6)
  v_mfma_f32_16x16x32_bf16 a[64:67], v[72:75], v[40:43], a[64:67]
  v_mfma_f32_16x16x32_bf16 a[68:71], v[72:75], v[44:47], a[68:71]
  v_mfma_f32_16x16x32_bf16 a[72:75], v[72:75], v[48:51], a[72:75]
  v_mfma_f32_16x16x32_bf16 a[76:79], v[72:75], v[52:55], a[76:79]
  ds_read_b64_tr_b16 v[72:73], v20 offset:7328
  ds_read_b64_tr_b16 v[74:75], v20 offset:10912
  s_waitcnt lgkmcnt(6)
  v_mfma_f32_16x16x32_bf16 a[80:83], v[76:79], v[40:43], a[80:83]
  v_mfma_f32_16x16x32_bf16 a[84:87], v[76:79], v[44:47], a[84:87]
  v_mfma_f32_16x16x32_bf16 a[88:91], v[76:79], v[48:51], a[88:91]
  v_mfma_f32_16x16x32_bf16 a[92:95], v[76:79], v[52:55], a[92:95]
  ds_read_b64_tr_b16 v[76:77], v20 offset:7360
  ds_read_b64_tr_b16 v[78:79], v20 offset:10944
  ds_read_b128 v[56:59], v15 offset:0
  s_waitcnt lgkmcnt(7)
  v_mfma_f32_16x16x32_bf16 a[96:99], v[80:83], v[40:43], a[96:99]
  v_mfma_f32_16x16x32_bf16 a[100:103], v[80:83], v[44:47], a[100:103]
  v_mfma_f32_16x16x32_bf16 a[104:107], v[80:83], v[48:51], a[104:107]
  v_mfma_f32_16x16x32_bf16 a[108:111], v[80:83], v[52:55], a[108:111]
  s_waitcnt lgkmcnt(0)
  s_waitcnt vmcnt(7)
  s_barrier
  v_add_u32 v21, s62, v13
  s_add_u32 s62, s62, 14336
  s_cmp_ge_u32 s62, 43008
  s_cselect_b32 s62, 0, s62
  s_add_u32 m0, s50, s63
  s_mov_b64 exec, s[46:47]
  buffer_load_dwordx4 v7, s[16:19], s41 offen offset:0 lds
  s_mov_b64 exec, -1
  s_mov_b64 exec, s[46:47]
  buffer_load_dwordx4 v8, s[16:19], s41 offen offset:896 lds
  s_mov_b64 exec, -1
  s_add_u32 s41, s41, 0x38000
  s_add_u32 s63, s63, 14336
  s_cmp_ge_u32 s63, 43008
  s_cselect_b32 s63, 0, s63
  ds_read_b64_tr_b16 v[80:81], v21 offset:64
  ds_read_b64_tr_b16 v[82:83], v21 offset:3648
  ds_read_b128 v[60:63], v15 offset:2048
  v_mfma_f32_16x16x32_bf16 a[112:115], v[84:87], v[40:43], a[112:115]
  v_mfma_f32_16x16x32_bf16 a[116:119], v[84:87], v[44:47], a[116:119]
  v_mfma_f32_16x16x32_bf16 a[120:123], v[84:87], v[48:51], a[120:123]
  v_mfma_f32_16x16x32_bf16 a[124:127], v[84:87], v[52:55], a[124:127]
  ds_read_b64_tr_b16 v[84:85], v21 offset:96
  ds_read_b64_tr_b16 v[86:87], v21 offset:3680
  ds_read_b128 v[64:67], v15 offset:4096
  v_mfma_f32_16x16x32_bf16 v[96:99], v[72:75], v[40:43], v[96:99]
  v_mfma_f32_16x16x32_bf16 v[100:103], v[72:75], v[44:47], v[100:103]
  v_mfma_f32_16x16x32_bf16 v[104:107], v[72:75], v[48:51], v[104:107]
  v_mfma_f32_16x16x32_bf16 v[108:111], v[72:75], v[52:55], v[108:111]
  ds_read_b64_tr_b16 v[72:73], v21 offset:128
  ds_read_b64_tr_b16 v[74:75], v21 offset:3712
  ds_read_b128 v[68:71], v15 offset:6144
  v_mfma_f32_16x16x32_bf16 v[112:115], v[76:79], v[40:43], v[112:115]
  v_mfma_f32_16x16x32_bf16 v[116:119], v[76:79], v[44:47], v[116:119]
  v_mfma_f32_16x16x32_bf16 v[120:123], v[76:79], v[48:51], v[120:123]
  v_mfma_f32_16x16x32_bf16 v[124:127], v[76:79], v[52:55], v[124:127]
  ds_read_b64_tr_b16 v[76:77], v21 offset:160
  ds_read_b64_tr_b16 v[78:79], v21 offset:3744
  s_waitcnt lgkmcnt(2)
  v_mfma_f32_16x16x32_bf16 a[0:3], v[80:83], v[56:59], a[0:3]
  v_mfma_f32_16x16x32_bf16 a[4:7], v[80:83], v[60:63], a[4:7]
  v_mfma_f32_16x16x32_bf16 a[8:11], v[80:83], v[64:67], a[8:11]
  v_mfma_f32_16x16x32_bf16 a[12:15], v[80:83], v[68:71], a[12:15]
  ds_read_b64_tr_b16 v[80:81], v21 offset:192
  ds_read_b64_tr_b16 v[82:83], v21 offset:3776
  v_mfma_f32_16x16x32_bf16 a[16:19], v[84:87], v[56:59], a[16:19]
  v_mfma_f32_16x16x32_bf16 a[20:23], v[84:87], v[60:63], a[20:23]
  v_mfma_f32_16x16x32_bf16 a[24:27], v[84:87], v[64:67], a[24:27]
  v_mfma_f32_16x16x32_bf16 a[28:31], v[84:87], v[68:71], a[28:31]
  ds_read_b64_tr_b16 v[84:85], v21 offset:7232
  ds_read_b64_tr_b16 v[86:87], v21 offset:10816
  v_mfma_f32_16x16x32_bf16 a[32:35], v[72:75], v[56:59], a[32:35]
  v_mfma_f32_16x16x32_bf16 a[36:39], v[72:75], v[60:63], a[36:39]
  v_mfma_f32_16x16x32_bf16 a[40:43], v[72:75], v[64:67], a[40:43]
  v_mfma_f32_16x16x32_bf16 a[44:47], v[72:75], v[68:71], a[44:47]
  ds_read_b64_tr_b16 v[72:73], v21 offset:7264
  ds_read_b64_tr_b16 v[74:75], v21 offset:10848
  s_waitcnt lgkmcnt(6)
  v_mfma_f32_16x16x32_bf16 a[48:51], v[76:79], v[56:59], a[48:51]
  v_mfma_f32_16x16x32_bf16 a[52:55], v[76:79], v[60:63], a[52:55]
  v_mfma_f32_16x16x32_bf16 a[56:59], v[76:79], v[64:67], a[56:59]
  v_mfma_f32_16x16x32_bf16 a[60:63], v[76:79], v[68:71], a[60:63]
  ds_read_b64_tr_b16 v[76:77], v21 offset:7296
  ds_read_b64_tr_b16 v[78:79], v21 offset:10880
  s_waitcnt lgkmcnt(6)
  v_mfma_f32_16x16x32_bf16 a[64:67], v[80:83], v[56:59], a[64:67]
  v_mfma_f32_16x16x32_bf16 a[68:71], v[80:83], v[60:63], a[68:71]
  v_mfma_f32_16x16x32_bf16 a[72:75], v[80:83], v[64:67], a[72:75]
  v_mfma_f32_16x16x32_bf16 a[76:79], v[80:83], v[68:71], a[76:79]
  ds_read_b64_tr_b16 v[80:81], v21 offset:7328
  ds_read_b64_tr_b16 v[82:83], v21 offset:10912
  s_waitcnt lgkmcnt(6)
  v_mfma_f32_16x16x32_bf16 a[80:83], v[84:87], v[56:59], a[80:83]
  v_mfma_f32_16x16x32_bf16 a[84:87], v[84:87], v[60:63], a[84:87]
  v_mfma_f32_16x16x32_bf16 a[88:91], v[84:87], v[64:67], a[88:91]
  v_mfma_f32_16x16x32_bf16 a[92:95], v[84:87], v[68:71], a[92:95]
  ds_read_b64_tr_b16 v[84:85], v21 offset:7360
  ds_read_b64_tr_b16 v[86:87], v21 offset:10944
  s_waitcnt lgkmcnt(6)
  v_mfma_f32_16x16x32_bf16 a[96:99], v[72:75], v[56:59], a[96:99]
  v_mfma_f32_16x16x32_bf16 a[100:103], v[72:75], v[60:63], a[100:103]
  v_mfma_f32_16x16x32_bf16 a[104:107], v[72:75], v[64:67], a[104:107]
  v_mfma_f32_16x16x32_bf16 a[108:111], v[72:75], v[68:71], a[108:111]
  s_waitcnt lgkmcnt(0)
  s_waitcnt vmcnt(6)
  s_barrier
  s_lshl_b32 s3, s52, 13
  s_add_u32 s3, s3, s60
  v_add_u32 v16, s3, v11
  s_add_u32 s3, s54, 98304
  v_add_u32 v19, s3, v11
  s_xor_b32 s3, s54, 0x2000
  s_add_u32 m0, s49, s3
  s_nop 0
  buffer_load_dwordx4 v6, s[12:15], s55 offen lds
  s_add_u32 s55, s55, 128
  s_add_u32 m0, s50, s63
  s_mov_b64 exec, s[46:47]
  buffer_load_dwordx4 v7, s[16:19], s41 offen offset:0 lds
  s_mov_b64 exec, -1
  s_mov_b64 exec, s[46:47]
  buffer_load_dwordx4 v8, s[16:19], s41 offen offset:896 lds
  s_mov_b64 exec, -1
  s_add_u32 s41, s41, 0x38000
  s_add_u32 s63, s63, 14336
  s_cmp_ge_u32 s63, 43008
  s_cselect_b32 s63, 0, s63
  v_add_u32 v21, s62, v13
  ds_read_b128 v[40:43], v16 offset:0
  ds_read_b128 v[44:47], v16 offset:2048
  ds_read_b64_tr_b16 v[72:73], v21 offset:64
  ds_read_b64_tr_b16 v[74:75], v21 offset:3648
  v_mfma_f32_16x16x32_bf16 a[112:115], v[76:79], v[56:59], a[112:115]
  v_mfma_f32_16x16x32_bf16 a[116:119], v[76:79], v[60:63], a[116:119]
  v_mfma_f32_16x16x32_bf16 a[120:123], v[76:79], v[64:67], a[120:123]
  v_mfma_f32_16x16x32_bf16 a[124:127], v[76:79], v[68:71], a[124:127]
  ds_read_b128 v[48:51], v16 offset:4096
  ds_read_b64_tr_b16 v[76:77], v21 offset:96
  ds_read_b64_tr_b16 v[78:79], v21 offset:3680
  v_mfma_f32_16x16x32_bf16 v[96:99], v[80:83], v[56:59], v[96:99]
  v_mfma_f32_16x16x32_bf16 v[100:103], v[80:83], v[60:63], v[100:103]
  v_mfma_f32_16x16x32_bf16 v[104:107], v[80:83], v[64:67], v[104:107]
  v_mfma_f32_16x16x32_bf16 v[108:111], v[80:83], v[68:71], v[108:111]
  ds_read_b128 v[52:55], v16 offset:6144
  ds_read_b64_tr_b16 v[80:81], v21 offset:128
  ds_read_b64_tr_b16 v[82:83], v21 offset:3712
  v_mfma_f32_16x16x32_bf16 v[112:115], v[84:87], v[56:59], v[112:115]
  v_mfma_f32_16x16x32_bf16 v[116:119], v[84:87], v[60:63], v[116:119]
  v_mfma_f32_16x16x32_bf16 v[120:123], v[84:87], v[64:67], v[120:123]
  v_mfma_f32_16x16x32_bf16 v[124:127], v[84:87], v[68:71], v[124:127]
  s_add_u32 s42, s42, 1
  s_cmp_lt_u32 s42, 16
  s_cbranch_scc1 K1_loop1
K1_main_end:
  s_waitcnt vmcnt(0)
  s_waitcnt lgkmcnt(0)
  s_barrier
  s_nop 7
  v_and_b32 v24, 15, v1
  v_mul_u32_u24 v24, 0xe0, v24
  v_lshrrev_b32 v25, 4, v1
  v_lshlrev_b32 v25, 3, v25
  v_add_u32 v24, v24, v25
  s_mul_i32 s3, s52, 14336
  s_add_u32 s3, s3, 73728
  v_add_u32 v30, s3, v24
  s_mov_b32 s6, 0xbfb8aa3b
  s_mov_b32 s7, 0xbfb8aa3b
  s_mov_b32 s28, s94
  s_and_b32 s29, s95, 0xffff
  s_mov_b32 s30, 0x100
  s_mov_b32 s31, 0x00020000
  s_cmp_eq_u32 s53, 0
  s_cbranch_scc1 K1_e0
  v_accvgpr_read_b32 v40, a0
  v_accvgpr_read_b32 v41, a1
  v_accvgpr_read_b32 v42, a2
  v_accvgpr_read_b32 v43, a3
  v_accvgpr_read_b32 v44, a80
  v_accvgpr_read_b32 v45, a81
  v_accvgpr_read_b32 v46, a82
  v_accvgpr_read_b32 v47, a83
  v_cvt_pk_bf16_f32 v56, v40, v41
  v_cvt_pk_bf16_f32 v58, v44, v45
  v_cvt_pk_bf16_f32 v57, v42, v43
  v_cvt_pk_bf16_f32 v59, v46, v47
  v_lshlrev_b32 v40, 16, v56
  v_and_b32 v41, 0xffff0000, v56
  v_lshlrev_b32 v42, 16, v57
  v_and_b32 v43, 0xffff0000, v57
  v_pk_mul_f32 v[48:49], v[40:41], s[6:7]
  v_pk_mul_f32 v[50:51], v[42:43], s[6:7]
  v_exp_f32 v48, v48
  v_exp_f32 v49, v49
  v_exp_f32 v50, v50
  v_exp_f32 v51, v51
  v_lshlrev_b32 v44, 16, v58
  v_and_b32 v45, 0xffff0000, v58
  v_lshlrev_b32 v46, 16, v59
  v_and_b32 v47, 0xffff0000, v59
  v_pk_add_f32 v[48:49], v[48:49], 1.0 op_sel_hi:[1,0]
  v_pk_add_f32 v[50:51], v[50:51], 1.0 op_sel_hi:[1,0]
  v_rcp_f32 v48, v48
  v_rcp_f32 v49, v49
  v_rcp_f32 v50, v50
  v_rcp_f32 v51, v51
  s_nop 0
  v_pk_mul_f32 v[48:49], v[48:49], v[40:41]
  v_pk_mul_f32 v[50:51], v[50:51], v[42:43]
  v_cvt_pk_bf16_f32 v56, v48, v49
  v_cvt_pk_bf16_f32 v57, v50, v51
  v_lshlrev_b32 v48, 16, v56
  v_and_b32 v49, 0xffff0000, v56
  v_lshlrev_b32 v50, 16, v57
  v_and_b32 v51, 0xffff0000, v57
  v_pk_mul_f32 v[48:49], v[48:49], v[44:45]
  v_pk_mul_f32 v[50:51], v[50:51], v[46:47]
  v_cvt_pk_bf16_f32 v56, v48, v49
  v_cvt_pk_bf16_f32 v57, v50, v51
  ds_write_b64 v30, v[56:57] offset:64
  v_accvgpr_read_b32 v40, a4
  v_accvgpr_read_b32 v41, a5
  v_accvgpr_read_b32 v42, a6
  v_accvgpr_read_b32 v43, a7
  v_accvgpr_read_b32 v44, a84
  v_accvgpr_read_b32 v45, a85
  v_accvgpr_read_b32 v46, a86
  v_accvgpr_read_b32 v47, a87
  v_cvt_pk_bf16_f32 v56, v40, v41
  v_cvt_pk_bf16_f32 v58, v44, v45
  v_cvt_pk_bf16_f32 v57, v42, v43
  v_cvt_pk_bf16_f32 v59, v46, v47
  v_lshlrev_b32 v40, 16, v56
  v_and_b32 v41, 0xffff0000, v56
  v_lshlrev_b32 v42, 16, v57
  v_and_b32 v43, 0xffff0000, v57
  v_pk_mul_f32 v[48:49], v[40:41], s[6:7]
  v_pk_mul_f32 v[50:51], v[42:43], s[6:7]
  v_exp_f32 v48, v48
  v_exp_f32 v49, v49
  v_exp_f32 v50, v50
  v_exp_f32 v51, v51
  v_lshlrev_b32 v44, 16, v58
  v_and_b32 v45, 0xffff0000, v58
  v_lshlrev_b32 v46, 16, v59
  v_and_b32 v47, 0xffff0000, v59
  v_pk_add_f32 v[48:49], v[48:49], 1.0 op_sel_hi:[1,0]
  v_pk_add_f32 v[50:51], v[50:51], 1.0 op_sel_hi:[1,0]
  v_rcp_f32 v48, v48
  v_rcp_f32 v49, v49
  v_rcp_f32 v50, v50
  v_rcp_f32 v51, v51
  s_nop 0
  v_pk_mul_f32 v[48:49], v[48:49], v[40:41]
  v_pk_mul_f32 v[50:51], v[50:51], v[42:43]
  v_cvt_pk_bf16_f32 v56, v48, v49
  v_cvt_pk_bf16_f32 v57, v50, v51
  v_lshlrev_b32 v48, 16, v56
  v_and_b32 v49, 0xffff0000, v56
  v_lshlrev_b32 v50, 16, v57
  v_and_b32 v51, 0xffff0000, v57
  v_pk_mul_f32 v[48:49], v[48:49], v[44:45]
  v_pk_mul_f32 v[50:51], v[50:51], v[46:47]
  v_cvt_pk_bf16_f32 v56, v48, v49
  v_cvt_pk_bf16_f32 v57, v50, v51
  ds_write_b64 v30, v[56:57] offset:3648
  v_accvgpr_read_b32 v40, a8
  v_accvgpr_read_b32 v41, a9
  v_accvgpr_read_b32 v42, a10
  v_accvgpr_read_b32 v43, a11
  v_accvgpr_read_b32 v44, a88
  v_accvgpr_read_b32 v45, a89
  v_accvgpr_read_b32 v46, a90
  v_accvgpr_read_b32 v47, a91
  v_cvt_pk_bf16_f32 v56, v40, v41
  v_cvt_pk_bf16_f32 v58, v44, v45
  v_cvt_pk_bf16_f32 v57, v42, v43
  v_cvt_pk_bf16_f32 v59, v46, v47
  v_lshlrev_b32 v40, 16, v56
  v_and_b32 v41, 0xffff0000, v56
  v_lshlrev_b32 v42, 16, v57
  v_and_b32 v43, 0xffff0000, v57
  v_pk_mul_f32 v[48:49], v[40:41], s[6:7]
  v_pk_mul_f32 v[50:51], v[42:43], s[6:7]
  v_exp_f32 v48, v48
  v_exp_f32 v49, v49
  v_exp_f32 v50, v50
  v_exp_f32 v51, v51
  v_lshlrev_b32 v44, 16, v58
  v_and_b32 v45, 0xffff0000, v58
  v_lshlrev_b32 v46, 16, v59
  v_and_b32 v47, 0xffff0000, v59
  v_pk_add_f32 v[48:49], v[48:49], 1.0 op_sel_hi:[1,0]
  v_pk_add_f32 v[50:51], v[50:51], 1.0 op_sel_hi:[1,0]
  v_rcp_f32 v48, v48
  v_rcp_f32 v49, v49
  v_rcp_f32 v50, v50
  v_rcp_f32 v51, v51
  s_nop 0
  v_pk_mul_f32 v[48:49], v[48:49], v[40:41]
  v_pk_mul_f32 v[50:51], v[50:51], v[42:43]
  v_cvt_pk_bf16_f32 v56, v48, v49
  v_cvt_pk_bf16_f32 v57, v50, v51
  v_lshlrev_b32 v48, 16, v56
  v_and_b32 v49, 0xffff0000, v56
  v_lshlrev_b32 v50, 16, v57
  v_and_b32 v51, 0xffff0000, v57
  v_pk_mul_f32 v[48:49], v[48:49], v[44:45]
  v_pk_mul_f32 v[50:51], v[50:51], v[46:47]
  v_cvt_pk_bf16_f32 v56, v48, v49
  v_cvt_pk_bf16_f32 v57, v50, v51
  ds_write_b64 v30, v[56:57] offset:7232
  v_accvgpr_read_b32 v40, a12
  v_accvgpr_read_b32 v41, a13
  v_accvgpr_read_b32 v42, a14
  v_accvgpr_read_b32 v43, a15
  v_accvgpr_read_b32 v44, a92
  v_accvgpr_read_b32 v45, a93
  v_accvgpr_read_b32 v46, a94
  v_accvgpr_read_b32 v47, a95
  v_cvt_pk_bf16_f32 v56, v40, v41
  v_cvt_pk_bf16_f32 v58, v44, v45
  v_cvt_pk_bf16_f32 v57, v42, v43
  v_cvt_pk_bf16_f32 v59, v46, v47
  v_lshlrev_b32 v40, 16, v56
  v_and_b32 v41, 0xffff0000, v56
  v_lshlrev_b32 v42, 16, v57
  v_and_b32 v43, 0xffff0000, v57
  v_pk_mul_f32 v[48:49], v[40:41], s[6:7]
  v_pk_mul_f32 v[50:51], v[42:43], s[6:7]
  v_exp_f32 v48, v48
  v_exp_f32 v49, v49
  v_exp_f32 v50, v50
  v_exp_f32 v51, v51
  v_lshlrev_b32 v44, 16, v58
  v_and_b32 v45, 0xffff0000, v58
  v_lshlrev_b32 v46, 16, v59
  v_and_b32 v47, 0xffff0000, v59
  v_pk_add_f32 v[48:49], v[48:49], 1.0 op_sel_hi:[1,0]
  v_pk_add_f32 v[50:51], v[50:51], 1.0 op_sel_hi:[1,0]
  v_rcp_f32 v48, v48
  v_rcp_f32 v49, v49
  v_rcp_f32 v50, v50
  v_rcp_f32 v51, v51
  s_nop 0
  v_pk_mul_f32 v[48:49], v[48:49], v[40:41]
  v_pk_mul_f32 v[50:51], v[50:51], v[42:43]
  v_cvt_pk_bf16_f32 v56, v48, v49
  v_cvt_pk_bf16_f32 v57, v50, v51
  v_lshlrev_b32 v48, 16, v56
  v_and_b32 v49, 0xffff0000, v56
  v_lshlrev_b32 v50, 16, v57
  v_and_b32 v51, 0xffff0000, v57
  v_pk_mul_f32 v[48:49], v[48:49], v[44:45]
  v_pk_mul_f32 v[50:51], v[50:51], v[46:47]
  v_cvt_pk_bf16_f32 v56, v48, v49
  v_cvt_pk_bf16_f32 v57, v50, v51
  ds_write_b64 v30, v[56:57] offset:10816
  v_accvgpr_read_b32 v40, a16
  v_accvgpr_read_b32 v41, a17
  v_accvgpr_read_b32 v42, a18
  v_accvgpr_read_b32 v43, a19
  v_accvgpr_read_b32 v44, a96
  v_accvgpr_read_b32 v45, a97
  v_accvgpr_read_b32 v46, a98
  v_accvgpr_read_b32 v47, a99
  v_cvt_pk_bf16_f32 v56, v40, v41
  v_cvt_pk_bf16_f32 v58, v44, v45
  v_cvt_pk_bf16_f32 v57, v42, v43
  v_cvt_pk_bf16_f32 v59, v46, v47
  v_lshlrev_b32 v40, 16, v56
  v_and_b32 v41, 0xffff0000, v56
  v_lshlrev_b32 v42, 16, v57
  v_and_b32 v43, 0xffff0000, v57
  v_pk_mul_f32 v[48:49], v[40:41], s[6:7]
  v_pk_mul_f32 v[50:51], v[42:43], s[6:7]
  v_exp_f32 v48, v48
  v_exp_f32 v49, v49
  v_exp_f32 v50, v50
  v_exp_f32 v51, v51
  v_lshlrev_b32 v44, 16, v58
  v_and_b32 v45, 0xffff0000, v58
  v_lshlrev_b32 v46, 16, v59
  v_and_b32 v47, 0xffff0000, v59
  v_pk_add_f32 v[48:49], v[48:49], 1.0 op_sel_hi:[1,0]
  v_pk_add_f32 v[50:51], v[50:51], 1.0 op_sel_hi:[1,0]
  v_rcp_f32 v48, v48
  v_rcp_f32 v49, v49
  v_rcp_f32 v50, v50
  v_rcp_f32 v51, v51
  s_nop 0
  v_pk_mul_f32 v[48:49], v[48:49], v[40:41]
  v_pk_mul_f32 v[50:51], v[50:51], v[42:43]
  v_cvt_pk_bf16_f32 v56, v48, v49
  v_cvt_pk_bf16_f32 v57, v50, v51
  v_lshlrev_b32 v48, 16, v56
  v_and_b32 v49, 0xffff0000, v56
  v_lshlrev_b32 v50, 16, v57
  v_and_b32 v51, 0xffff0000, v57
  v_pk_mul_f32 v[48:49], v[48:49], v[44:45]
  v_pk_mul_f32 v[50:51], v[50:51], v[46:47]
  v_cvt_pk_bf16_f32 v56, v48, v49
  v_cvt_pk_bf16_f32 v57, v50, v51
  ds_write_b64 v30, v[56:57] offset:96
  s_barrier
  v_accvgpr_read_b32 v40, a20
  v_accvgpr_read_b32 v41, a21
  v_accvgpr_read_b32 v42, a22
  v_accvgpr_read_b32 v43, a23
  v_accvgpr_read_b32 v44, a100
  v_accvgpr_read_b32 v45, a101
  v_accvgpr_read_b32 v46, a102
  v_accvgpr_read_b32 v47, a103
  v_cvt_pk_bf16_f32 v56, v40, v41
  v_cvt_pk_bf16_f32 v58, v44, v45
  v_cvt_pk_bf16_f32 v57, v42, v43
  v_cvt_pk_bf16_f32 v59, v46, v47
  v_lshlrev_b32 v40, 16, v56
  v_and_b32 v41, 0xffff0000, v56
  v_lshlrev_b32 v42, 16, v57
  v_and_b32 v43, 0xffff0000, v57
  v_pk_mul_f32 v[48:49], v[40:41], s[6:7]
  v_pk_mul_f32 v[50:51], v[42:43], s[6:7]
  v_exp_f32 v48, v48
  v_exp_f32 v49, v49
  v_exp_f32 v50, v50
  v_exp_f32 v51, v51
  v_lshlrev_b32 v44, 16, v58
  v_and_b32 v45, 0xffff0000, v58
  v_lshlrev_b32 v46, 16, v59
  v_and_b32 v47, 0xffff0000, v59
  v_pk_add_f32 v[48:49], v[48:49], 1.0 op_sel_hi:[1,0]
  v_pk_add_f32 v[50:51], v[50:51], 1.0 op_sel_hi:[1,0]
  v_rcp_f32 v48, v48
  v_rcp_f32 v49, v49
  v_rcp_f32 v50, v50
  v_rcp_f32 v51, v51
  s_nop 0
  v_pk_mul_f32 v[48:49], v[48:49], v[40:41]
  v_pk_mul_f32 v[50:51], v[50:51], v[42:43]
  v_cvt_pk_bf16_f32 v56, v48, v49
  v_cvt_pk_bf16_f32 v57, v50, v51
  v_lshlrev_b32 v48, 16, v56
  v_and_b32 v49, 0xffff0000, v56
  v_lshlrev_b32 v50, 16, v57
  v_and_b32 v51, 0xffff0000, v57
  v_pk_mul_f32 v[48:49], v[48:49], v[44:45]
  v_pk_mul_f32 v[50:51], v[50:51], v[46:47]
  v_cvt_pk_bf16_f32 v56, v48, v49
  v_cvt_pk_bf16_f32 v57, v50, v51
  ds_write_b64 v30, v[56:57] offset:3680
  v_accvgpr_read_b32 v40, a24
  v_accvgpr_read_b32 v41, a25
  v_accvgpr_read_b32 v42, a26
  v_accvgpr_read_b32 v43, a27
  v_accvgpr_read_b32 v44, a104
  v_accvgpr_read_b32 v45, a105
  v_accvgpr_read_b32 v46, a106
  v_accvgpr_read_b32 v47, a107
  v_cvt_pk_bf16_f32 v56, v40, v41
  v_cvt_pk_bf16_f32 v58, v44, v45
  v_cvt_pk_bf16_f32 v57, v42, v43
  v_cvt_pk_bf16_f32 v59, v46, v47
  v_lshlrev_b32 v40, 16, v56
  v_and_b32 v41, 0xffff0000, v56
  v_lshlrev_b32 v42, 16, v57
  v_and_b32 v43, 0xffff0000, v57
  v_pk_mul_f32 v[48:49], v[40:41], s[6:7]
  v_pk_mul_f32 v[50:51], v[42:43], s[6:7]
  v_exp_f32 v48, v48
  v_exp_f32 v49, v49
  v_exp_f32 v50, v50
  v_exp_f32 v51, v51
  v_lshlrev_b32 v44, 16, v58
  v_and_b32 v45, 0xffff0000, v58
  v_lshlrev_b32 v46, 16, v59
  v_and_b32 v47, 0xffff0000, v59
  v_pk_add_f32 v[48:49], v[48:49], 1.0 op_sel_hi:[1,0]
  v_pk_add_f32 v[50:51], v[50:51], 1.0 op_sel_hi:[1,0]
  v_rcp_f32 v48, v48
  v_rcp_f32 v49, v49
  v_rcp_f32 v50, v50
  v_rcp_f32 v51, v51
  s_nop 0
  v_pk_mul_f32 v[48:49], v[48:49], v[40:41]
  v_pk_mul_f32 v[50:51], v[50:51], v[42:43]
  v_cvt_pk_bf16_f32 v56, v48, v49
  v_cvt_pk_bf16_f32 v57, v50, v51
  v_lshlrev_b32 v48, 16, v56
  v_and_b32 v49, 0xffff0000, v56
  v_lshlrev_b32 v50, 16, v57
  v_and_b32 v51, 0xffff0000, v57
  v_pk_mul_f32 v[48:49], v[48:49], v[44:45]
  v_pk_mul_f32 v[50:51], v[50:51], v[46:47]
  v_cvt_pk_bf16_f32 v56, v48, v49
  v_cvt_pk_bf16_f32 v57, v50, v51
  ds_write_b64 v30, v[56:57] offset:7264
  v_accvgpr_read_b32 v40, a28
  v_accvgpr_read_b32 v41, a29
  v_accvgpr_read_b32 v42, a30
  v_accvgpr_read_b32 v43, a31
  v_accvgpr_read_b32 v44, a108
  v_accvgpr_read_b32 v45, a109
  v_accvgpr_read_b32 v46, a110
  v_accvgpr_read_b32 v47, a111
  v_cvt_pk_bf16_f32 v56, v40, v41
  v_cvt_pk_bf16_f32 v58, v44, v45
  v_cvt_pk_bf16_f32 v57, v42, v43
  v_cvt_pk_bf16_f32 v59, v46, v47
  v_lshlrev_b32 v40, 16, v56
  v_and_b32 v41, 0xffff0000, v56
  v_lshlrev_b32 v42, 16, v57
  v_and_b32 v43, 0xffff0000, v57
  v_pk_mul_f32 v[48:49], v[40:41], s[6:7]
  v_pk_mul_f32 v[50:51], v[42:43], s[6:7]
  v_exp_f32 v48, v48
  v_exp_f32 v49, v49
  v_exp_f32 v50, v50
  v_exp_f32 v51, v51
  v_lshlrev_b32 v44, 16, v58
  v_and_b32 v45, 0xffff0000, v58
  v_lshlrev_b32 v46, 16, v59
  v_and_b32 v47, 0xffff0000, v59
  v_pk_add_f32 v[48:49], v[48:49], 1.0 op_sel_hi:[1,0]
  v_pk_add_f32 v[50:51], v[50:51], 1.0 op_sel_hi:[1,0]
  v_rcp_f32 v48, v48
  v_rcp_f32 v49, v49
  v_rcp_f32 v50, v50
  v_rcp_f32 v51, v51
  s_nop 0
  v_pk_mul_f32 v[48:49], v[48:49], v[40:41]
  v_pk_mul_f32 v[50:51], v[50:51], v[42:43]
  v_cvt_pk_bf16_f32 v56, v48, v49
  v_cvt_pk_bf16_f32 v57, v50, v51
  v_lshlrev_b32 v48, 16, v56
  v_and_b32 v49, 0xffff0000, v56
  v_lshlrev_b32 v50, 16, v57
  v_and_b32 v51, 0xffff0000, v57
  v_pk_mul_f32 v[48:49], v[48:49], v[44:45]
  v_pk_mul_f32 v[50:51], v[50:51], v[46:47]
  v_cvt_pk_bf16_f32 v56, v48, v49
  v_cvt_pk_bf16_f32 v57, v50, v51
  ds_write_b64 v30, v[56:57] offset:10848
  v_accvgpr_read_b32 v40, a32
  v_accvgpr_read_b32 v41, a33
  v_accvgpr_read_b32 v42, a34
  v_accvgpr_read_b32 v43, a35
  v_accvgpr_read_b32 v44, a112
  v_accvgpr_read_b32 v45, a113
  v_accvgpr_read_b32 v46, a114
  v_accvgpr_read_b32 v47, a115
  v_cvt_pk_bf16_f32 v56, v40, v41
  v_cvt_pk_bf16_f32 v58, v44, v45
  v_cvt_pk_bf16_f32 v57, v42, v43
  v_cvt_pk_bf16_f32 v59, v46, v47
  v_lshlrev_b32 v40, 16, v56
  v_and_b32 v41, 0xffff0000, v56
  v_lshlrev_b32 v42, 16, v57
  v_and_b32 v43, 0xffff0000, v57
  v_pk_mul_f32 v[48:49], v[40:41], s[6:7]
  v_pk_mul_f32 v[50:51], v[42:43], s[6:7]
  v_exp_f32 v48, v48
  v_exp_f32 v49, v49
  v_exp_f32 v50, v50
  v_exp_f32 v51, v51
  v_lshlrev_b32 v44, 16, v58
  v_and_b32 v45, 0xffff0000, v58
  v_lshlrev_b32 v46, 16, v59
  v_and_b32 v47, 0xffff0000, v59
  v_pk_add_f32 v[48:49], v[48:49], 1.0 op_sel_hi:[1,0]
  v_pk_add_f32 v[50:51], v[50:51], 1.0 op_sel_hi:[1,0]
  v_rcp_f32 v48, v48
  v_rcp_f32 v49, v49
  v_rcp_f32 v50, v50
  v_rcp_f32 v51, v51
  s_nop 0
  v_pk_mul_f32 v[48:49], v[48:49], v[40:41]
  v_pk_mul_f32 v[50:51], v[50:51], v[42:43]
  v_cvt_pk_bf16_f32 v56, v48, v49
  v_cvt_pk_bf16_f32 v57, v50, v51
  v_lshlrev_b32 v48, 16, v56
  v_and_b32 v49, 0xffff0000, v56
  v_lshlrev_b32 v50, 16, v57
  v_and_b32 v51, 0xffff0000, v57
  v_pk_mul_f32 v[48:49], v[48:49], v[44:45]
  v_pk_mul_f32 v[50:51], v[50:51], v[46:47]
  v_cvt_pk_bf16_f32 v56, v48, v49
  v_cvt_pk_bf16_f32 v57, v50, v51
  ds_write_b64 v30, v[56:57] offset:128
  v_accvgpr_read_b32 v40, a36
  v_accvgpr_read_b32 v41, a37
  v_accvgpr_read_b32 v42, a38
  v_accvgpr_read_b32 v43, a39
  v_accvgpr_read_b32 v44, a116
  v_accvgpr_read_b32 v45, a117
  v_accvgpr_read_b32 v46, a118
  v_accvgpr_read_b32 v47, a119
  v_cvt_pk_bf16_f32 v56, v40, v41
  v_cvt_pk_bf16_f32 v58, v44, v45
  v_cvt_pk_bf16_f32 v57, v42, v43
  v_cvt_pk_bf16_f32 v59, v46, v47
  v_lshlrev_b32 v40, 16, v56
  v_and_b32 v41, 0xffff0000, v56
  v_lshlrev_b32 v42, 16, v57
  v_and_b32 v43, 0xffff0000, v57
  v_pk_mul_f32 v[48:49], v[40:41], s[6:7]
  v_pk_mul_f32 v[50:51], v[42:43], s[6:7]
  v_exp_f32 v48, v48
  v_exp_f32 v49, v49
  v_exp_f32 v50, v50
  v_exp_f32 v51, v51
  v_lshlrev_b32 v44, 16, v58
  v_and_b32 v45, 0xffff0000, v58
  v_lshlrev_b32 v46, 16, v59
  v_and_b32 v47, 0xffff0000, v59
  v_pk_add_f32 v[48:49], v[48:49], 1.0 op_sel_hi:[1,0]
  v_pk_add_f32 v[50:51], v[50:51], 1.0 op_sel_hi:[1,0]
  v_rcp_f32 v48, v48
  v_rcp_f32 v49, v49
  v_rcp_f32 v50, v50
  v_rcp_f32 v51, v51
  s_nop 0
  v_pk_mul_f32 v[48:49], v[48:49], v[40:41]
  v_pk_mul_f32 v[50:51], v[50:51], v[42:43]
  v_cvt_pk_bf16_f32 v56, v48, v49
  v_cvt_pk_bf16_f32 v57, v50, v51
  v_lshlrev_b32 v48, 16, v56
  v_and_b32 v49, 0xffff0000, v56
  v_lshlrev_b32 v50, 16, v57
  v_and_b32 v51, 0xffff0000, v57
  v_pk_mul_f32 v[48:49], v[48:49], v[44:45]
  v_pk_mul_f32 v[50:51], v[50:51], v[46:47]
  v_cvt_pk_bf16_f32 v56, v48, v49
  v_cvt_pk_bf16_f32 v57, v50, v51
  ds_write_b64 v30, v[56:57] offset:3712
  v_accvgpr_read_b32 v40, a40
  v_accvgpr_read_b32 v41, a41
  v_accvgpr_read_b32 v42, a42
  v_accvgpr_read_b32 v43, a43
  v_accvgpr_read_b32 v44, a120
  v_accvgpr_read_b32 v45, a121
  v_accvgpr_read_b32 v46, a122
  v_accvgpr_read_b32 v47, a123
  v_cvt_pk_bf16_f32 v56, v40, v41
  v_cvt_pk_bf16_f32 v58, v44, v45
  v_cvt_pk_bf16_f32 v57, v42, v43
  v_cvt_pk_bf16_f32 v59, v46, v47
  v_lshlrev_b32 v40, 16, v56
  v_and_b32 v41, 0xffff0000, v56
  v_lshlrev_b32 v42, 16, v57
  v_and_b32 v43, 0xffff0000, v57
  v_pk_mul_f32 v[48:49], v[40:41], s[6:7]
  v_pk_mul_f32 v[50:51], v[42:43], s[6:7]
  v_exp_f32 v48, v48
  v_exp_f32 v49, v49
  v_exp_f32 v50, v50
  v_exp_f32 v51, v51
  v_lshlrev_b32 v44, 16, v58
  v_and_b32 v45, 0xffff0000, v58
  v_lshlrev_b32 v46, 16, v59
  v_and_b32 v47, 0xffff0000, v59
  v_pk_add_f32 v[48:49], v[48:49], 1.0 op_sel_hi:[1,0]
  v_pk_add_f32 v[50:51], v[50:51], 1.0 op_sel_hi:[1,0]
  v_rcp_f32 v48, v48
  v_rcp_f32 v49, v49
  v_rcp_f32 v50, v50
  v_rcp_f32 v51, v51
  s_nop 0
  v_pk_mul_f32 v[48:49], v[48:49], v[40:41]
  v_pk_mul_f32 v[50:51], v[50:51], v[42:43]
  v_cvt_pk_bf16_f32 v56, v48, v49
  v_cvt_pk_bf16_f32 v57, v50, v51
  v_lshlrev_b32 v48, 16, v56
  v_and_b32 v49, 0xffff0000, v56
  v_lshlrev_b32 v50, 16, v57
  v_and_b32 v51, 0xffff0000, v57
  v_pk_mul_f32 v[48:49], v[48:49], v[44:45]
  v_pk_mul_f32 v[50:51], v[50:51], v[46:47]
  v_cvt_pk_bf16_f32 v56, v48, v49
  v_cvt_pk_bf16_f32 v57, v50, v51
  ds_write_b64 v30, v[56:57] offset:7296
  s_barrier
  v_accvgpr_read_b32 v40, a44
  v_accvgpr_read_b32 v41, a45
  v_accvgpr_read_b32 v42, a46
  v_accvgpr_read_b32 v43, a47
  v_accvgpr_read_b32 v44, a124
  v_accvgpr_read_b32 v45, a125
  v_accvgpr_read_b32 v46, a126
  v_accvgpr_read_b32 v47, a127
  v_cvt_pk_bf16_f32 v56, v40, v41
  v_cvt_pk_bf16_f32 v58, v44, v45
  v_cvt_pk_bf16_f32 v57, v42, v43
  v_cvt_pk_bf16_f32 v59, v46, v47
  v_lshlrev_b32 v40, 16, v56
  v_and_b32 v41, 0xffff0000, v56
  v_lshlrev_b32 v42, 16, v57
  v_and_b32 v43, 0xffff0000, v57
  v_pk_mul_f32 v[48:49], v[40:41], s[6:7]
  v_pk_mul_f32 v[50:51], v[42:43], s[6:7]
  v_exp_f32 v48, v48
  v_exp_f32 v49, v49
  v_exp_f32 v50, v50
  v_exp_f32 v51, v51
  v_lshlrev_b32 v44, 16, v58
  v_and_b32 v45, 0xffff0000, v58
  v_lshlrev_b32 v46, 16, v59
  v_and_b32 v47, 0xffff0000, v59
  v_pk_add_f32 v[48:49], v[48:49], 1.0 op_sel_hi:[1,0]
  v_pk_add_f32 v[50:51], v[50:51], 1.0 op_sel_hi:[1,0]
  v_rcp_f32 v48, v48
  v_rcp_f32 v49, v49
  v_rcp_f32 v50, v50
  v_rcp_f32 v51, v51
  s_nop 0
  v_pk_mul_f32 v[48:49], v[48:49], v[40:41]
  v_pk_mul_f32 v[50:51], v[50:51], v[42:43]
  v_cvt_pk_bf16_f32 v56, v48, v49
  v_cvt_pk_bf16_f32 v57, v50, v51
  v_lshlrev_b32 v48, 16, v56
  v_and_b32 v49, 0xffff0000, v56
  v_lshlrev_b32 v50, 16, v57
  v_and_b32 v51, 0xffff0000, v57
  v_pk_mul_f32 v[48:49], v[48:49], v[44:45]
  v_pk_mul_f32 v[50:51], v[50:51], v[46:47]
  v_cvt_pk_bf16_f32 v56, v48, v49
  v_cvt_pk_bf16_f32 v57, v50, v51
  ds_write_b64 v30, v[56:57] offset:10880
  v_accvgpr_read_b32 v40, a48
  v_accvgpr_read_b32 v41, a49
  v_accvgpr_read_b32 v42, a50
  v_accvgpr_read_b32 v43, a51
  v_cvt_pk_bf16_f32 v56, v40, v41
  v_cvt_pk_bf16_f32 v58, v96, v97
  v_cvt_pk_bf16_f32 v57, v42, v43
  v_cvt_pk_bf16_f32 v59, v98, v99
  v_lshlrev_b32 v40, 16, v56
  v_and_b32 v41, 0xffff0000, v56
  v_lshlrev_b32 v42, 16, v57
  v_and_b32 v43, 0xffff0000, v57
  v_pk_mul_f32 v[48:49], v[40:41], s[6:7]
  v_pk_mul_f32 v[50:51], v[42:43], s[6:7]
  v_exp_f32 v48, v48
  v_exp_f32 v49, v49
  v_exp_f32 v50, v50
  v_exp_f32 v51, v51
  v_lshlrev_b32 v44, 16, v58
  v_and_b32 v45, 0xffff0000, v58
  v_lshlrev_b32 v46, 16, v59
  v_and_b32 v47, 0xffff0000, v59
  v_pk_add_f32 v[48:49], v[48:49], 1.0 op_sel_hi:[1,0]
  v_pk_add_f32 v[50:51], v[50:51], 1.0 op_sel_hi:[1,0]
  v_rcp_f32 v48, v48
  v_rcp_f32 v49, v49
  v_rcp_f32 v50, v50
  v_rcp_f32 v51, v51
  s_nop 0
  v_pk_mul_f32 v[48:49], v[48:49], v[40:41]
  v_pk_mul_f32 v[50:51], v[50:51], v[42:43]
  v_cvt_pk_bf16_f32 v56, v48, v49
  v_cvt_pk_bf16_f32 v57, v50, v51
  v_lshlrev_b32 v48, 16, v56
  v_and_b32 v49, 0xffff0000, v56
  v_lshlrev_b32 v50, 16, v57
  v_and_b32 v51, 0xffff0000, v57
  v_pk_mul_f32 v[48:49], v[48:49], v[44:45]
  v_pk_mul_f32 v[50:51], v[50:51], v[46:47]
  v_cvt_pk_bf16_f32 v56, v48, v49
  v_cvt_pk_bf16_f32 v57, v50, v51
  ds_write_b64 v30, v[56:57] offset:160
  v_accvgpr_read_b32 v40, a52
  v_accvgpr_read_b32 v41, a53
  v_accvgpr_read_b32 v42, a54
  v_accvgpr_read_b32 v43, a55
  v_cvt_pk_bf16_f32 v56, v40, v41
  v_cvt_pk_bf16_f32 v58, v100, v101
  v_cvt_pk_bf16_f32 v57, v42, v43
  v_cvt_pk_bf16_f32 v59, v102, v103
  v_lshlrev_b32 v40, 16, v56
  v_and_b32 v41, 0xffff0000, v56
  v_lshlrev_b32 v42, 16, v57
  v_and_b32 v43, 0xffff0000, v57
  v_pk_mul_f32 v[48:49], v[40:41], s[6:7]
  v_pk_mul_f32 v[50:51], v[42:43], s[6:7]
  v_exp_f32 v48, v48
  v_exp_f32 v49, v49
  v_exp_f32 v50, v50
  v_exp_f32 v51, v51
  v_lshlrev_b32 v44, 16, v58
  v_and_b32 v45, 0xffff0000, v58
  v_lshlrev_b32 v46, 16, v59
  v_and_b32 v47, 0xffff0000, v59
  v_pk_add_f32 v[48:49], v[48:49], 1.0 op_sel_hi:[1,0]
  v_pk_add_f32 v[50:51], v[50:51], 1.0 op_sel_hi:[1,0]
  v_rcp_f32 v48, v48
  v_rcp_f32 v49, v49
  v_rcp_f32 v50, v50
  v_rcp_f32 v51, v51
  s_nop 0
  v_pk_mul_f32 v[48:49], v[48:49], v[40:41]
  v_pk_mul_f32 v[50:51], v[50:51], v[42:43]
  v_cvt_pk_bf16_f32 v56, v48, v49
  v_cvt_pk_bf16_f32 v57, v50, v51
  v_lshlrev_b32 v48, 16, v56
  v_and_b32 v49, 0xffff0000, v56
  v_lshlrev_b32 v50, 16, v57
  v_and_b32 v51, 0xffff0000, v57
  v_pk_mul_f32 v[48:49], v[48:49], v[44:45]
  v_pk_mul_f32 v[50:51], v[50:51], v[46:47]
  v_cvt_pk_bf16_f32 v56, v48, v49
  v_cvt_pk_bf16_f32 v57, v50, v51
  ds_write_b64 v30, v[56:57] offset:3744
  v_accvgpr_read_b32 v40, a56
  v_accvgpr_read_b32 v41, a57
  v_accvgpr_read_b32 v42, a58
  v_accvgpr_read_b32 v43, a59
  v_cvt_pk_bf16_f32 v56, v40, v41
  v_cvt_pk_bf16_f32 v58, v104, v105
  v_cvt_pk_bf16_f32 v57, v42, v43
  v_cvt_pk_bf16_f32 v59, v106, v107
  v_lshlrev_b32 v40, 16, v56
  v_and_b32 v41, 0xffff0000, v56
  v_lshlrev_b32 v42, 16, v57
  v_and_b32 v43, 0xffff0000, v57
  v_pk_mul_f32 v[48:49], v[40:41], s[6:7]
  v_pk_mul_f32 v[50:51], v[42:43], s[6:7]
  v_exp_f32 v48, v48
  v_exp_f32 v49, v49
  v_exp_f32 v50, v50
  v_exp_f32 v51, v51
  v_lshlrev_b32 v44, 16, v58
  v_and_b32 v45, 0xffff0000, v58
  v_lshlrev_b32 v46, 16, v59
  v_and_b32 v47, 0xffff0000, v59
  v_pk_add_f32 v[48:49], v[48:49], 1.0 op_sel_hi:[1,0]
  v_pk_add_f32 v[50:51], v[50:51], 1.0 op_sel_hi:[1,0]
  v_rcp_f32 v48, v48
  v_rcp_f32 v49, v49
  v_rcp_f32 v50, v50
  v_rcp_f32 v51, v51
  s_nop 0
  v_pk_mul_f32 v[48:49], v[48:49], v[40:41]
  v_pk_mul_f32 v[50:51], v[50:51], v[42:43]
  v_cvt_pk_bf16_f32 v56, v48, v49
  v_cvt_pk_bf16_f32 v57, v50, v51
  v_lshlrev_b32 v48, 16, v56
  v_and_b32 v49, 0xffff0000, v56
  v_lshlrev_b32 v50, 16, v57
  v_and_b32 v51, 0xffff0000, v57
  v_pk_mul_f32 v[48:49], v[48:49], v[44:45]
  v_pk_mul_f32 v[50:51], v[50:51], v[46:47]
  v_cvt_pk_bf16_f32 v56, v48, v49
  v_cvt_pk_bf16_f32 v57, v50, v51
  ds_write_b64 v30, v[56:57] offset:7328
  v_accvgpr_read_b32 v40, a60
  v_accvgpr_read_b32 v41, a61
  v_accvgpr_read_b32 v42, a62
  v_accvgpr_read_b32 v43, a63
  v_cvt_pk_bf16_f32 v56, v40, v41
  v_cvt_pk_bf16_f32 v58, v108, v109
  v_cvt_pk_bf16_f32 v57, v42, v43
  v_cvt_pk_bf16_f32 v59, v110, v111
  v_lshlrev_b32 v40, 16, v56
  v_and_b32 v41, 0xffff0000, v56
  v_lshlrev_b32 v42, 16, v57
  v_and_b32 v43, 0xffff0000, v57
  v_pk_mul_f32 v[48:49], v[40:41], s[6:7]
  v_pk_mul_f32 v[50:51], v[42:43], s[6:7]
  v_exp_f32 v48, v48
  v_exp_f32 v49, v49
  v_exp_f32 v50, v50
  v_exp_f32 v51, v51
  v_lshlrev_b32 v44, 16, v58
  v_and_b32 v45, 0xffff0000, v58
  v_lshlrev_b32 v46, 16, v59
  v_and_b32 v47, 0xffff0000, v59
  v_pk_add_f32 v[48:49], v[48:49], 1.0 op_sel_hi:[1,0]
  v_pk_add_f32 v[50:51], v[50:51], 1.0 op_sel_hi:[1,0]
  v_rcp_f32 v48, v48
  v_rcp_f32 v49, v49
  v_rcp_f32 v50, v50
  v_rcp_f32 v51, v51
  s_nop 0
  v_pk_mul_f32 v[48:49], v[48:49], v[40:41]
  v_pk_mul_f32 v[50:51], v[50:51], v[42:43]
  v_cvt_pk_bf16_f32 v56, v48, v49
  v_cvt_pk_bf16_f32 v57, v50, v51
  v_lshlrev_b32 v48, 16, v56
  v_and_b32 v49, 0xffff0000, v56
  v_lshlrev_b32 v50, 16, v57
  v_and_b32 v51, 0xffff0000, v57
  v_pk_mul_f32 v[48:49], v[48:49], v[44:45]
  v_pk_mul_f32 v[50:51], v[50:51], v[46:47]
  v_cvt_pk_bf16_f32 v56, v48, v49
  v_cvt_pk_bf16_f32 v57, v50, v51
  ds_write_b64 v30, v[56:57] offset:10912
  v_accvgpr_read_b32 v40, a64
  v_accvgpr_read_b32 v41, a65
  v_accvgpr_read_b32 v42, a66
  v_accvgpr_read_b32 v43, a67
  v_cvt_pk_bf16_f32 v56, v40, v41
  v_cvt_pk_bf16_f32 v58, v112, v113
  v_cvt_pk_bf16_f32 v57, v42, v43
  v_cvt_pk_bf16_f32 v59, v114, v115
  v_lshlrev_b32 v40, 16, v56
  v_and_b32 v41, 0xffff0000, v56
  v_lshlrev_b32 v42, 16, v57
  v_and_b32 v43, 0xffff0000, v57
  v_pk_mul_f32 v[48:49], v[40:41], s[6:7]
  v_pk_mul_f32 v[50:51], v[42:43], s[6:7]
  v_exp_f32 v48, v48
  v_exp_f32 v49, v49
  v_exp_f32 v50, v50
  v_exp_f32 v51, v51
  v_lshlrev_b32 v44, 16, v58
  v_and_b32 v45, 0xffff0000, v58
  v_lshlrev_b32 v46, 16, v59
  v_and_b32 v47, 0xffff0000, v59
  v_pk_add_f32 v[48:49], v[48:49], 1.0 op_sel_hi:[1,0]
  v_pk_add_f32 v[50:51], v[50:51], 1.0 op_sel_hi:[1,0]
  v_rcp_f32 v48, v48
  v_rcp_f32 v49, v49
  v_rcp_f32 v50, v50
  v_rcp_f32 v51, v51
  s_nop 0
  v_pk_mul_f32 v[48:49], v[48:49], v[40:41]
  v_pk_mul_f32 v[50:51], v[50:51], v[42:43]
  v_cvt_pk_bf16_f32 v56, v48, v49
  v_cvt_pk_bf16_f32 v57, v50, v51
  v_lshlrev_b32 v48, 16, v56
  v_and_b32 v49, 0xffff0000, v56
  v_lshlrev_b32 v50, 16, v57
  v_and_b32 v51, 0xffff0000, v57
  v_pk_mul_f32 v[48:49], v[48:49], v[44:45]
  v_pk_mul_f32 v[50:51], v[50:51], v[46:47]
  v_cvt_pk_bf16_f32 v56, v48, v49
  v_cvt_pk_bf16_f32 v57, v50, v51
  ds_write_b64 v30, v[56:57] offset:192
  v_accvgpr_read_b32 v40, a68
  v_accvgpr_read_b32 v41, a69
  v_accvgpr_read_b32 v42, a70
  v_accvgpr_read_b32 v43, a71
  v_cvt_pk_bf16_f32 v56, v40, v41
  v_cvt_pk_bf16_f32 v58, v116, v117
  v_cvt_pk_bf16_f32 v57, v42, v43
  v_cvt_pk_bf16_f32 v59, v118, v119
  v_lshlrev_b32 v40, 16, v56
  v_and_b32 v41, 0xffff0000, v56
  v_lshlrev_b32 v42, 16, v57
  v_and_b32 v43, 0xffff0000, v57
  v_pk_mul_f32 v[48:49], v[40:41], s[6:7]
  v_pk_mul_f32 v[50:51], v[42:43], s[6:7]
  v_exp_f32 v48, v48
  v_exp_f32 v49, v49
  v_exp_f32 v50, v50
  v_exp_f32 v51, v51
  v_lshlrev_b32 v44, 16, v58
  v_and_b32 v45, 0xffff0000, v58
  v_lshlrev_b32 v46, 16, v59
  v_and_b32 v47, 0xffff0000, v59
  v_pk_add_f32 v[48:49], v[48:49], 1.0 op_sel_hi:[1,0]
  v_pk_add_f32 v[50:51], v[50:51], 1.0 op_sel_hi:[1,0]
  v_rcp_f32 v48, v48
  v_rcp_f32 v49, v49
  v_rcp_f32 v50, v50
  v_rcp_f32 v51, v51
  s_nop 0
  v_pk_mul_f32 v[48:49], v[48:49], v[40:41]
  v_pk_mul_f32 v[50:51], v[50:51], v[42:43]
  v_cvt_pk_bf16_f32 v56, v48, v49
  v_cvt_pk_bf16_f32 v57, v50, v51
  v_lshlrev_b32 v48, 16, v56
  v_and_b32 v49, 0xffff0000, v56
  v_lshlrev_b32 v50, 16, v57
  v_and_b32 v51, 0xffff0000, v57
  v_pk_mul_f32 v[48:49], v[48:49], v[44:45]
  v_pk_mul_f32 v[50:51], v[50:51], v[46:47]
  v_cvt_pk_bf16_f32 v56, v48, v49
  v_cvt_pk_bf16_f32 v57, v50, v51
  ds_write_b64 v30, v[56:57] offset:3776
  v_accvgpr_read_b32 v40, a72
  v_accvgpr_read_b32 v41, a73
  v_accvgpr_read_b32 v42, a74
  v_accvgpr_read_b32 v43, a75
  v_cvt_pk_bf16_f32 v56, v40, v41
  v_cvt_pk_bf16_f32 v58, v120, v121
  v_cvt_pk_bf16_f32 v57, v42, v43
  v_cvt_pk_bf16_f32 v59, v122, v123
  v_lshlrev_b32 v40, 16, v56
  v_and_b32 v41, 0xffff0000, v56
  v_lshlrev_b32 v42, 16, v57
  v_and_b32 v43, 0xffff0000, v57
  v_pk_mul_f32 v[48:49], v[40:41], s[6:7]
  v_pk_mul_f32 v[50:51], v[42:43], s[6:7]
  v_exp_f32 v48, v48
  v_exp_f32 v49, v49
  v_exp_f32 v50, v50
  v_exp_f32 v51, v51
  v_lshlrev_b32 v44, 16, v58
  v_and_b32 v45, 0xffff0000, v58
  v_lshlrev_b32 v46, 16, v59
  v_and_b32 v47, 0xffff0000, v59
  v_pk_add_f32 v[48:49], v[48:49], 1.0 op_sel_hi:[1,0]
  v_pk_add_f32 v[50:51], v[50:51], 1.0 op_sel_hi:[1,0]
  v_rcp_f32 v48, v48
  v_rcp_f32 v49, v49
  v_rcp_f32 v50, v50
  v_rcp_f32 v51, v51
  s_nop 0
  v_pk_mul_f32 v[48:49], v[48:49], v[40:41]
  v_pk_mul_f32 v[50:51], v[50:51], v[42:43]
  v_cvt_pk_bf16_f32 v56, v48, v49
  v_cvt_pk_bf16_f32 v57, v50, v51
  v_lshlrev_b32 v48, 16, v56
  v_and_b32 v49, 0xffff0000, v56
  v_lshlrev_b32 v50, 16, v57
  v_and_b32 v51, 0xffff0000, v57
  v_pk_mul_f32 v[48:49], v[48:49], v[44:45]
  v_pk_mul_f32 v[50:51], v[50:51], v[46:47]
  v_cvt_pk_bf16_f32 v56, v48, v49
  v_cvt_pk_bf16_f32 v57, v50, v51
  ds_write_b64 v30, v[56:57] offset:7360
  v_accvgpr_read_b32 v40, a76
  v_accvgpr_read_b32 v41, a77
  v_accvgpr_read_b32 v42, a78
  v_accvgpr_read_b32 v43, a79
  v_cvt_pk_bf16_f32 v56, v40, v41
  v_cvt_pk_bf16_f32 v58, v124, v125
  v_cvt_pk_bf16_f32 v57, v42, v43
  v_cvt_pk_bf16_f32 v59, v126, v127
  v_lshlrev_b32 v40, 16, v56
  v_and_b32 v41, 0xffff0000, v56
  v_lshlrev_b32 v42, 16, v57
  v_and_b32 v43, 0xffff0000, v57
  v_pk_mul_f32 v[48:49], v[40:41], s[6:7]
  v_pk_mul_f32 v[50:51], v[42:43], s[6:7]
  v_exp_f32 v48, v48
  v_exp_f32 v49, v49
  v_exp_f32 v50, v50
  v_exp_f32 v51, v51
  v_lshlrev_b32 v44, 16, v58
  v_and_b32 v45, 0xffff0000, v58
  v_lshlrev_b32 v46, 16, v59
  v_and_b32 v47, 0xffff0000, v59
  v_pk_add_f32 v[48:49], v[48:49], 1.0 op_sel_hi:[1,0]
  v_pk_add_f32 v[50:51], v[50:51], 1.0 op_sel_hi:[1,0]
  v_rcp_f32 v48, v48
  v_rcp_f32 v49, v49
  v_rcp_f32 v50, v50
  v_rcp_f32 v51, v51
  s_nop 0
  v_pk_mul_f32 v[48:49], v[48:49], v[40:41]
  v_pk_mul_f32 v[50:51], v[50:51], v[42:43]
  v_cvt_pk_bf16_f32 v56, v48, v49
  v_cvt_pk_bf16_f32 v57, v50, v51
  v_lshlrev_b32 v48, 16, v56
  v_and_b32 v49, 0xffff0000, v56
  v_lshlrev_b32 v50, 16, v57
  v_and_b32 v51, 0xffff0000, v57
  v_pk_mul_f32 v[48:49], v[48:49], v[44:45]
  v_pk_mul_f32 v[50:51], v[50:51], v[46:47]
  v_cvt_pk_bf16_f32 v56, v48, v49
  v_cvt_pk_bf16_f32 v57, v50, v51
  ds_write_b64 v30, v[56:57] offset:10944
  s_branch K1_e_join
K1_e0:
  v_and_b32 v24, 15, v1
  v_lshlrev_b32 v25, 4, v24
  v_add_u32 v25, 0x26800, v25
  ds_read_b128 v[40:43], v25
  ds_read_b128 v[44:47], v25 offset:256
  s_movk_i32 s3, 2064
  v_mul_lo_u32 v24, s3, v24
  v_lshrrev_b32 v25, 4, v1
  v_lshlrev_b32 v25, 5, v25
  v_add_u32 v24, v24, v25
  s_lshl_b32 s3, s52, 9
  s_add_u32 s3, s3, 4096
  v_add_u32 v24, s3, v24
  s_waitcnt lgkmcnt(0)
  v_accvgpr_read_b32 v72, a0
  v_accvgpr_read_b32 v76, a32
  v_accvgpr_read_b32 v73, a1
  v_accvgpr_read_b32 v77, a33
  v_accvgpr_read_b32 v74, a2
  v_accvgpr_read_b32 v78, a34
  v_accvgpr_read_b32 v75, a3
  v_accvgpr_read_b32 v79, a35
  v_mul_f32 v64, v42, v72
  v_mul_f32 v65, v42, v76
  v_fma_f32 v64, -v43, v76, v64
  v_fma_f32 v65, v43, v72, v65
  v_mul_f32 v66, v42, v73
  v_mul_f32 v67, v42, v77
  v_fma_f32 v66, -v43, v77, v66
  v_fma_f32 v67, v43, v73, v67
  v_mul_f32 v68, v42, v74
  v_mul_f32 v69, v42, v78
  v_fma_f32 v68, -v43, v78, v68
  v_fma_f32 v69, v43, v74, v69
  v_mul_f32 v70, v42, v75
  v_mul_f32 v71, v42, v79
  v_fma_f32 v70, -v43, v79, v70
  v_fma_f32 v71, v43, v75, v71
  ds_write_b128 v24, v[64:67] offset:0
  ds_write_b128 v24, v[68:71] offset:16
  v_accvgpr_read_b32 v88, a4
  v_accvgpr_read_b32 v92, a36
  v_accvgpr_read_b32 v89, a5
  v_accvgpr_read_b32 v93, a37
  v_accvgpr_read_b32 v90, a6
  v_accvgpr_read_b32 v94, a38
  v_accvgpr_read_b32 v91, a7
  v_accvgpr_read_b32 v95, a39
  v_mul_f32 v80, v42, v88
  v_mul_f32 v81, v42, v92
  v_fma_f32 v80, -v43, v92, v80
  v_fma_f32 v81, v43, v88, v81
  v_mul_f32 v82, v42, v89
  v_mul_f32 v83, v42, v93
  v_fma_f32 v82, -v43, v93, v82
  v_fma_f32 v83, v43, v89, v83
  v_mul_f32 v84, v42, v90
  v_mul_f32 v85, v42, v94
  v_fma_f32 v84, -v43, v94, v84
  v_fma_f32 v85, v43, v90, v85
  v_mul_f32 v86, v42, v91
  v_mul_f32 v87, v42, v95
  v_fma_f32 v86, -v43, v95, v86
  v_fma_f32 v87, v43, v91, v87
  ds_write_b128 v24, v[80:83] offset:128
  ds_write_b128 v24, v[84:87] offset:144
  v_accvgpr_read_b32 v72, a8
  v_accvgpr_read_b32 v76, a40
  v_accvgpr_read_b32 v73, a9
  v_accvgpr_read_b32 v77, a41
  v_accvgpr_read_b32 v74, a10
  v_accvgpr_read_b32 v78, a42
  v_accvgpr_read_b32 v75, a11
  v_accvgpr_read_b32 v79, a43
  v_mul_f32 v64, v42, v72
  v_mul_f32 v65, v42, v76
  v_fma_f32 v64, -v43, v76, v64
  v_fma_f32 v65, v43, v72, v65
  v_mul_f32 v66, v42, v73
  v_mul_f32 v67, v42, v77
  v_fma_f32 v66, -v43, v77, v66
  v_fma_f32 v67, v43, v73, v67
  v_mul_f32 v68, v42, v74
  v_mul_f32 v69, v42, v78
  v_fma_f32 v68, -v43, v78, v68
  v_fma_f32 v69, v43, v74, v69
  v_mul_f32 v70, v42, v75
  v_mul_f32 v71, v42, v79
  v_fma_f32 v70, -v43, v79, v70
  v_fma_f32 v71, v43, v75, v71
  ds_write_b128 v24, v[64:67] offset:256
  ds_write_b128 v24, v[68:71] offset:272
  v_accvgpr_read_b32 v88, a12
  v_accvgpr_read_b32 v92, a44
  v_accvgpr_read_b32 v89, a13
  v_accvgpr_read_b32 v93, a45
  v_accvgpr_read_b32 v90, a14
  v_accvgpr_read_b32 v94, a46
  v_accvgpr_read_b32 v91, a15
  v_accvgpr_read_b32 v95, a47
  v_mul_f32 v80, v42, v88
  v_mul_f32 v81, v42, v92
  v_fma_f32 v80, -v43, v92, v80
  v_fma_f32 v81, v43, v88, v81
  v_mul_f32 v82, v42, v89
  v_mul_f32 v83, v42, v93
  v_fma_f32 v82, -v43, v93, v82
  v_fma_f32 v83, v43, v89, v83
  v_mul_f32 v84, v42, v90
  v_mul_f32 v85, v42, v94
  v_fma_f32 v84, -v43, v94, v84
  v_fma_f32 v85, v43, v90, v85
  v_mul_f32 v86, v42, v91
  v_mul_f32 v87, v42, v95
  v_fma_f32 v86, -v43, v95, v86
  v_fma_f32 v87, v43, v91, v87
  ds_write_b128 v24, v[80:83] offset:384
  ds_write_b128 v24, v[84:87] offset:400
  v_accvgpr_read_b32 v72, a16
  v_accvgpr_read_b32 v76, a48
  v_accvgpr_read_b32 v73, a17
  v_accvgpr_read_b32 v77, a49
  v_accvgpr_read_b32 v74, a18
  v_accvgpr_read_b32 v78, a50
  v_accvgpr_read_b32 v75, a19
  v_accvgpr_read_b32 v79, a51
  v_mul_f32 v64, v46, v72
  v_mul_f32 v65, v46, v76
  v_fma_f32 v64, -v47, v76, v64
  v_fma_f32 v65, v47, v72, v65
  v_mul_f32 v66, v46, v73
  v_mul_f32 v67, v46, v77
  v_fma_f32 v66, -v47, v77, v66
  v_fma_f32 v67, v47, v73, v67
  v_mul_f32 v68, v46, v74
  v_mul_f32 v69, v46, v78
  v_fma_f32 v68, -v47, v78, v68
  v_fma_f32 v69, v47, v74, v69
  v_mul_f32 v70, v46, v75
  v_mul_f32 v71, v46, v79
  v_fma_f32 v70, -v47, v79, v70
  v_fma_f32 v71, v47, v75, v71
  ds_write_b128 v24, v[64:67] offset:33024
  ds_write_b128 v24, v[68:71] offset:33040
  v_accvgpr_read_b32 v88, a20
  v_accvgpr_read_b32 v92, a52
  v_accvgpr_read_b32 v89, a21
  v_accvgpr_read_b32 v93, a53
  v_accvgpr_read_b32 v90, a22
  v_accvgpr_read_b32 v94, a54
  v_accvgpr_read_b32 v91, a23
  v_accvgpr_read_b32 v95, a55
  v_mul_f32 v80, v46, v88
  v_mul_f32 v81, v46, v92
  v_fma_f32 v80, -v47, v92, v80
  v_fma_f32 v81, v47, v88, v81
  v_mul_f32 v82, v46, v89
  v_mul_f32 v83, v46, v93
  v_fma_f32 v82, -v47, v93, v82
  v_fma_f32 v83, v47, v89, v83
  v_mul_f32 v84, v46, v90
  v_mul_f32 v85, v46, v94
  v_fma_f32 v84, -v47, v94, v84
  v_fma_f32 v85, v47, v90, v85
  v_mul_f32 v86, v46, v91
  v_mul_f32 v87, v46, v95
  v_fma_f32 v86, -v47, v95, v86
  v_fma_f32 v87, v47, v91, v87
  ds_write_b128 v24, v[80:83] offset:33152
  ds_write_b128 v24, v[84:87] offset:33168
  v_accvgpr_read_b32 v72, a24
  v_accvgpr_read_b32 v76, a56
  v_accvgpr_read_b32 v73, a25
  v_accvgpr_read_b32 v77, a57
  v_accvgpr_read_b32 v74, a26
  v_accvgpr_read_b32 v78, a58
  v_accvgpr_read_b32 v75, a27
  v_accvgpr_read_b32 v79, a59
  v_mul_f32 v64, v46, v72
  v_mul_f32 v65, v46, v76
  v_fma_f32 v64, -v47, v76, v64
  v_fma_f32 v65, v47, v72, v65
  v_mul_f32 v66, v46, v73
  v_mul_f32 v67, v46, v77
  v_fma_f32 v66, -v47, v77, v66
  v_fma_f32 v67, v47, v73, v67
  v_mul_f32 v68, v46, v74
  v_mul_f32 v69, v46, v78
  v_fma_f32 v68, -v47, v78, v68
  v_fma_f32 v69, v47, v74, v69
  v_mul_f32 v70, v46, v75
  v_mul_f32 v71, v46, v79
  v_fma_f32 v70, -v47, v79, v70
  v_fma_f32 v71, v47, v75, v71
  ds_write_b128 v24, v[64:67] offset:33280
  ds_write_b128 v24, v[68:71] offset:33296
  v_accvgpr_read_b32 v88, a28
  v_accvgpr_read_b32 v92, a60
  v_accvgpr_read_b32 v89, a29
  v_accvgpr_read_b32 v93, a61
  v_accvgpr_read_b32 v90, a30
  v_accvgpr_read_b32 v94, a62
  v_accvgpr_read_b32 v91, a31
  v_accvgpr_read_b32 v95, a63
  v_mul_f32 v80, v46, v88
  v_mul_f32 v81, v46, v92
  v_fma_f32 v80, -v47, v92, v80
  v_fma_f32 v81, v47, v88, v81
  v_mul_f32 v82, v46, v89
  v_mul_f32 v83, v46, v93
  v_fma_f32 v82, -v47, v93, v82
  v_fma_f32 v83, v47, v89, v83
  v_mul_f32 v84, v46, v90
  v_mul_f32 v85, v46, v94
  v_fma_f32 v84, -v47, v94, v84
  v_fma_f32 v85, v47, v90, v85
  v_mul_f32 v86, v46, v91
  v_mul_f32 v87, v46, v95
  v_fma_f32 v86, -v47, v95, v86
  v_fma_f32 v87, v47, v91, v87
  ds_write_b128 v24, v[80:83] offset:33408
  ds_write_b128 v24, v[84:87] offset:33424
  s_waitcnt lgkmcnt(0)
  s_barrier
  v_and_b32 v24, 31, v0
  v_lshlrev_b32 v25, 4, v24
  v_add_u32 v25, 0x26800, v25
  ds_read_b64 v[32:33], v25
  s_movk_i32 s3, 2064
  v_mul_lo_u32 v24, s3, v24
  v_lshrrev_b32 v31, 5, v0
  v_lshlrev_b32 v26, 8, v31
  v_add_u32 v24, v24, v26
  v_add_u32 v24, 4096, v24
  ds_read_b128 v[64:67], v24 offset:0
  ds_read_b128 v[68:71], v24 offset:16
  ds_read_b128 v[72:75], v24 offset:32
  ds_read_b128 v[76:79], v24 offset:48
  ds_read_b128 v[80:83], v24 offset:64
  ds_read_b128 v[84:87], v24 offset:80
  ds_read_b128 v[88:91], v24 offset:96
  ds_read_b128 v[92:95], v24 offset:112
  ds_read_b128 v[96:99], v24 offset:128
  ds_read_b128 v[100:103], v24 offset:144
  ds_read_b128 v[104:107], v24 offset:160
  ds_read_b128 v[108:111], v24 offset:176
  ds_read_b128 v[112:115], v24 offset:192
  ds_read_b128 v[116:119], v24 offset:208
  ds_read_b128 v[120:123], v24 offset:224
  ds_read_b128 v[124:127], v24 offset:240
  s_waitcnt lgkmcnt(0)
  v_fma_f32 v28, v32, v64, v66
  v_fma_f32 v60, v32, v96, v98
  v_fma_f32 v29, v32, v65, v67
  v_fma_f32 v61, v32, v97, v99
  v_fma_f32 v28, -v33, v65, v28
  v_fma_f32 v60, -v33, v97, v60
  v_fma_f32 v67, v33, v64, v29
  v_fma_f32 v99, v33, v96, v61
  v_mov_b32 v66, v28
  v_mov_b32 v98, v60
  v_fma_f32 v28, v32, v66, v68
  v_fma_f32 v60, v32, v98, v100
  v_fma_f32 v29, v32, v67, v69
  v_fma_f32 v61, v32, v99, v101
  v_fma_f32 v28, -v33, v67, v28
  v_fma_f32 v60, -v33, v99, v60
  v_fma_f32 v69, v33, v66, v29
  v_fma_f32 v101, v33, v98, v61
  v_mov_b32 v68, v28
  v_mov_b32 v100, v60
  v_fma_f32 v28, v32, v68, v70
  v_fma_f32 v60, v32, v100, v102
  v_fma_f32 v29, v32, v69, v71
  v_fma_f32 v61, v32, v101, v103
  v_fma_f32 v28, -v33, v69, v28
  v_fma_f32 v60, -v33, v101, v60
  v_fma_f32 v71, v33, v68, v29
  v_fma_f32 v103, v33, v100, v61
  v_mov_b32 v70, v28
  v_mov_b32 v102, v60
  v_fma_f32 v28, v32, v70, v72
  v_fma_f32 v60, v32, v102, v104
  v_fma_f32 v29, v32, v71, v73
  v_fma_f32 v61, v32, v103, v105
  v_fma_f32 v28, -v33, v71, v28
  v_fma_f32 v60, -v33, v103, v60
  v_fma_f32 v73, v33, v70, v29
  v_fma_f32 v105, v33, v102, v61
  v_mov_b32 v72, v28
  v_mov_b32 v104, v60
  v_fma_f32 v28, v32, v72, v74
  v_fma_f32 v60, v32, v104, v106
  v_fma_f32 v29, v32, v73, v75
  v_fma_f32 v61, v32, v105, v107
  v_fma_f32 v28, -v33, v73, v28
  v_fma_f32 v60, -v33, v105, v60
  v_fma_f32 v75, v33, v72, v29
  v_fma_f32 v107, v33, v104, v61
  v_mov_b32 v74, v28
  v_mov_b32 v106, v60
  v_fma_f32 v28, v32, v74, v76
  v_fma_f32 v60, v32, v106, v108
  v_fma_f32 v29, v32, v75, v77
  v_fma_f32 v61, v32, v107, v109
  v_fma_f32 v28, -v33, v75, v28
  v_fma_f32 v60, -v33, v107, v60
  v_fma_f32 v77, v33, v74, v29
  v_fma_f32 v109, v33, v106, v61
  v_mov_b32 v76, v28
  v_mov_b32 v108, v60
  v_fma_f32 v28, v32, v76, v78
  v_fma_f32 v60, v32, v108, v110
  v_fma_f32 v29, v32, v77, v79
  v_fma_f32 v61, v32, v109, v111
  v_fma_f32 v28, -v33, v77, v28
  v_fma_f32 v60, -v33, v109, v60
  v_fma_f32 v79, v33, v76, v29
  v_fma_f32 v111, v33, v108, v61
  v_mov_b32 v78, v28
  v_mov_b32 v110, v60
  v_fma_f32 v28, v32, v78, v80
  v_fma_f32 v60, v32, v110, v112
  v_fma_f32 v29, v32, v79, v81
  v_fma_f32 v61, v32, v111, v113
  v_fma_f32 v28, -v33, v79, v28
  v_fma_f32 v60, -v33, v111, v60
  v_fma_f32 v81, v33, v78, v29
  v_fma_f32 v113, v33, v110, v61
  v_mov_b32 v80, v28
  v_mov_b32 v112, v60
  v_fma_f32 v28, v32, v80, v82
  v_fma_f32 v60, v32, v112, v114
  v_fma_f32 v29, v32, v81, v83
  v_fma_f32 v61, v32, v113, v115
  v_fma_f32 v28, -v33, v81, v28
  v_fma_f32 v60, -v33, v113, v60
  v_fma_f32 v83, v33, v80, v29
  v_fma_f32 v115, v33, v112, v61
  v_mov_b32 v82, v28
  v_mov_b32 v114, v60
  v_fma_f32 v28, v32, v82, v84
  v_fma_f32 v60, v32, v114, v116
  v_fma_f32 v29, v32, v83, v85
  v_fma_f32 v61, v32, v115, v117
  v_fma_f32 v28, -v33, v83, v28
  v_fma_f32 v60, -v33, v115, v60
  v_fma_f32 v85, v33, v82, v29
  v_fma_f32 v117, v33, v114, v61
  v_mov_b32 v84, v28
  v_mov_b32 v116, v60
  v_fma_f32 v28, v32, v84, v86
  v_fma_f32 v60, v32, v116, v118
  v_fma_f32 v29, v32, v85, v87
  v_fma_f32 v61, v32, v117, v119
  v_fma_f32 v28, -v33, v85, v28
  v_fma_f32 v60, -v33, v117, v60
  v_fma_f32 v87, v33, v84, v29
  v_fma_f32 v119, v33, v116, v61
  v_mov_b32 v86, v28
  v_mov_b32 v118, v60
  v_fma_f32 v28, v32, v86, v88
  v_fma_f32 v60, v32, v118, v120
  v_fma_f32 v29, v32, v87, v89
  v_fma_f32 v61, v32, v119, v121
  v_fma_f32 v28, -v33, v87, v28
  v_fma_f32 v60, -v33, v119, v60
  v_fma_f32 v89, v33, v86, v29
  v_fma_f32 v121, v33, v118, v61
  v_mov_b32 v88, v28
  v_mov_b32 v120, v60
  v_fma_f32 v28, v32, v88, v90
  v_fma_f32 v60, v32, v120, v122
  v_fma_f32 v29, v32, v89, v91
  v_fma_f32 v61, v32, v121, v123
  v_fma_f32 v28, -v33, v89, v28
  v_fma_f32 v60, -v33, v121, v60
  v_fma_f32 v91, v33, v88, v29
  v_fma_f32 v123, v33, v120, v61
  v_mov_b32 v90, v28
  v_mov_b32 v122, v60
  v_fma_f32 v28, v32, v90, v92
  v_fma_f32 v60, v32, v122, v124
  v_fma_f32 v29, v32, v91, v93
  v_fma_f32 v61, v32, v123, v125
  v_fma_f32 v28, -v33, v91, v28
  v_fma_f32 v60, -v33, v123, v60
  v_fma_f32 v93, v33, v90, v29
  v_fma_f32 v125, v33, v122, v61
  v_mov_b32 v92, v28
  v_mov_b32 v124, v60
  v_fma_f32 v28, v32, v92, v94
  v_fma_f32 v60, v32, v124, v126
  v_fma_f32 v29, v32, v93, v95
  v_fma_f32 v61, v32, v125, v127
  v_fma_f32 v28, -v33, v93, v28
  v_fma_f32 v60, -v33, v125, v60
  v_fma_f32 v95, v33, v92, v29
  v_fma_f32 v127, v33, v124, v61
  v_mov_b32 v94, v28
  v_mov_b32 v126, v60
  v_mov_b32 v34, v32
  v_mov_b32 v35, v33
  v_mul_f32 v28, v34, v34
  v_fma_f32 v28, -v35, v35, v28
  v_mul_f32 v29, v34, v35
  v_fma_f32 v35, v35, v34, v29
  v_mov_b32 v34, v28
  v_mul_f32 v28, v34, v34
  v_fma_f32 v28, -v35, v35, v28
  v_mul_f32 v29, v34, v35
  v_fma_f32 v35, v35, v34, v29
  v_mov_b32 v34, v28
  v_mul_f32 v28, v34, v34
  v_fma_f32 v28, -v35, v35, v28
  v_mul_f32 v29, v34, v35
  v_fma_f32 v35, v35, v34, v29
  v_mov_b32 v34, v28
  v_mul_f32 v28, v34, v34
  v_fma_f32 v28, -v35, v35, v28
  v_mul_f32 v29, v34, v35
  v_fma_f32 v35, v35, v34, v29
  v_mov_b32 v34, v28
  v_fma_f32 v28, v34, v94, v126
  v_fma_f32 v29, v34, v95, v127
  v_fma_f32 v28, -v35, v95, v28
  v_fma_f32 v41, v35, v94, v29
  v_mov_b32 v40, v28
  v_lshlrev_b32 v26, 3, v0
  ds_write_b64 v26, v[40:41] offset:0
  v_mul_f32 v28, v34, v34
  v_fma_f32 v28, -v35, v35, v28
  v_mul_f32 v29, v34, v35
  v_fma_f32 v63, v35, v34, v29
  v_mov_b32 v62, v28
  s_waitcnt lgkmcnt(0)
  s_barrier
  v_and_b32 v26, 31, v0
  v_lshlrev_b32 v26, 3, v26
  ds_read_b64 v[44:45], v26 offset:0
  ds_read_b64 v[46:47], v26 offset:256
  ds_read_b64 v[48:49], v26 offset:512
  ds_read_b64 v[50:51], v26 offset:768
  ds_read_b64 v[52:53], v26 offset:1024
  ds_read_b64 v[54:55], v26 offset:1280
  ds_read_b64 v[56:57], v26 offset:1536
  ds_read_b64 v[58:59], v26 offset:1792
  v_mov_b32 v40, 0
  v_mov_b32 v41, 0
  v_mov_b32 v36, 0
  v_mov_b32 v37, 0
  v_mov_b32 v42, 1.0
  v_mov_b32 v43, 0
  v_mov_b32 v38, 1.0
  v_mov_b32 v39, 0
  s_waitcnt lgkmcnt(0)
  v_fma_f32 v28, v62, v40, v44
  v_fma_f32 v29, v62, v41, v45
  v_fma_f32 v28, -v63, v41, v28
  v_fma_f32 v41, v63, v40, v29
  v_mov_b32 v40, v28
  v_mul_f32 v28, v42, v62
  v_fma_f32 v28, -v43, v63, v28
  v_mul_f32 v29, v42, v63
  v_fma_f32 v43, v43, v62, v29
  v_mov_b32 v42, v28
  v_cmp_eq_u32 vcc, 1, v31
  s_nop 1
  v_cndmask_b32 v36, v36, v40, vcc
  v_cndmask_b32 v37, v37, v41, vcc
  v_cndmask_b32 v38, v38, v42, vcc
  v_cndmask_b32 v39, v39, v43, vcc
  v_fma_f32 v28, v62, v40, v46
  v_fma_f32 v29, v62, v41, v47
  v_fma_f32 v28, -v63, v41, v28
  v_fma_f32 v41, v63, v40, v29
  v_mov_b32 v40, v28
  v_mul_f32 v28, v42, v62
  v_fma_f32 v28, -v43, v63, v28
  v_mul_f32 v29, v42, v63
  v_fma_f32 v43, v43, v62, v29
  v_mov_b32 v42, v28
  v_cmp_eq_u32 vcc, 2, v31
  s_nop 1
  v_cndmask_b32 v36, v36, v40, vcc
  v_cndmask_b32 v37, v37, v41, vcc
  v_cndmask_b32 v38, v38, v42, vcc
  v_cndmask_b32 v39, v39, v43, vcc
  v_fma_f32 v28, v62, v40, v48
  v_fma_f32 v29, v62, v41, v49
  v_fma_f32 v28, -v63, v41, v28
  v_fma_f32 v41, v63, v40, v29
  v_mov_b32 v40, v28
  v_mul_f32 v28, v42, v62
  v_fma_f32 v28, -v43, v63, v28
  v_mul_f32 v29, v42, v63
  v_fma_f32 v43, v43, v62, v29
  v_mov_b32 v42, v28
  v_cmp_eq_u32 vcc, 3, v31
  s_nop 1
  v_cndmask_b32 v36, v36, v40, vcc
  v_cndmask_b32 v37, v37, v41, vcc
  v_cndmask_b32 v38, v38, v42, vcc
  v_cndmask_b32 v39, v39, v43, vcc
  v_fma_f32 v28, v62, v40, v50
  v_fma_f32 v29, v62, v41, v51
  v_fma_f32 v28, -v63, v41, v28
  v_fma_f32 v41, v63, v40, v29
  v_mov_b32 v40, v28
  v_mul_f32 v28, v42, v62
  v_fma_f32 v28, -v43, v63, v28
  v_mul_f32 v29, v42, v63
  v_fma_f32 v43, v43, v62, v29
  v_mov_b32 v42, v28
  v_cmp_eq_u32 vcc, 4, v31
  s_nop 1
  v_cndmask_b32 v36, v36, v40, vcc
  v_cndmask_b32 v37, v37, v41, vcc
  v_cndmask_b32 v38, v38, v42, vcc
  v_cndmask_b32 v39, v39, v43, vcc
  v_fma_f32 v28, v62, v40, v52
  v_fma_f32 v29, v62, v41, v53
  v_fma_f32 v28, -v63, v41, v28
  v_fma_f32 v41, v63, v40, v29
  v_mov_b32 v40, v28
  v_mul_f32 v28, v42, v62
  v_fma_f32 v28, -v43, v63, v28
  v_mul_f32 v29, v42, v63
  v_fma_f32 v43, v43, v62, v29
  v_mov_b32 v42, v28
  v_cmp_eq_u32 vcc, 5, v31
  s_nop 1
  v_cndmask_b32 v36, v36, v40, vcc
  v_cndmask_b32 v37, v37, v41, vcc
  v_cndmask_b32 v38, v38, v42, vcc
  v_cndmask_b32 v39, v39, v43, vcc
  v_fma_f32 v28, v62, v40, v54
  v_fma_f32 v29, v62, v41, v55
  v_fma_f32 v28, -v63, v41, v28
  v_fma_f32 v41, v63, v40, v29
  v_mov_b32 v40, v28
  v_mul_f32 v28, v42, v62
  v_fma_f32 v28, -v43, v63, v28
  v_mul_f32 v29, v42, v63
  v_fma_f32 v43, v43, v62, v29
  v_mov_b32 v42, v28
  v_cmp_eq_u32 vcc, 6, v31
  s_nop 1
  v_cndmask_b32 v36, v36, v40, vcc
  v_cndmask_b32 v37, v37, v41, vcc
  v_cndmask_b32 v38, v38, v42, vcc
  v_cndmask_b32 v39, v39, v43, vcc
  v_fma_f32 v28, v62, v40, v56
  v_fma_f32 v29, v62, v41, v57
  v_fma_f32 v28, -v63, v41, v28
  v_fma_f32 v41, v63, v40, v29
  v_mov_b32 v40, v28
  v_mul_f32 v28, v42, v62
  v_fma_f32 v28, -v43, v63, v28
  v_mul_f32 v29, v42, v63
  v_fma_f32 v43, v43, v62, v29
  v_mov_b32 v42, v28
  v_cmp_eq_u32 vcc, 7, v31
  s_nop 1
  v_cndmask_b32 v36, v36, v40, vcc
  v_cndmask_b32 v37, v37, v41, vcc
  v_cndmask_b32 v38, v38, v42, vcc
  v_cndmask_b32 v39, v39, v43, vcc
  v_fma_f32 v28, v62, v40, v58
  v_fma_f32 v29, v62, v41, v59
  v_fma_f32 v28, -v63, v41, v28
  v_fma_f32 v41, v63, v40, v29
  v_mov_b32 v40, v28
  s_lshl_b32 s3, s44, 10
  s_lshl_b32 s4, s45, 5
  s_add_u32 s3, s3, s4
  s_lshl_b32 s3, s3, 3
  s_add_u32 s3, s3, 0x2000000
  v_add_u32 v26, s3, v26
  s_cmp_lg_u32 s43, 0
  s_cbranch_scc1 K1_pub_done
  v_cmp_gt_u32 vcc, 32, v0
  s_and_saveexec_b64 s[4:5], vcc
  buffer_store_dwordx2 v[40:41], v26, s[24:27], 0 offen sc1
  s_mov_b64 exec, s[4:5]
  s_waitcnt vmcnt(0)
  s_lshl_b32 s3, 1, s44
  v_mov_b32 v27, s3
  s_lshl_b32 s3, s45, 2
  v_mov_b32 v26, s3
  v_cmp_eq_u32 vcc, 0, v0
  s_and_saveexec_b64 s[4:5], vcc
  buffer_atomic_or v27, v26, s[28:31], 0 offen sc1
  s_mov_b64 exec, s[4:5]
K1_pub_done:
  v_accvgpr_read_b32 v40, a64
  v_accvgpr_read_b32 v41, a65
  v_accvgpr_read_b32 v42, a66
  v_accvgpr_read_b32 v43, a67
  v_accvgpr_read_b32 v44, a96
  v_accvgpr_read_b32 v45, a97
  v_accvgpr_read_b32 v46, a98
  v_accvgpr_read_b32 v47, a99
  v_cvt_pk_bf16_f32 v56, v40, v41
  v_cvt_pk_bf16_f32 v58, v44, v45
  v_cvt_pk_bf16_f32 v57, v42, v43
  v_cvt_pk_bf16_f32 v59, v46, v47
  v_lshlrev_b32 v40, 16, v56
  v_and_b32 v41, 0xffff0000, v56
  v_lshlrev_b32 v42, 16, v57
  v_and_b32 v43, 0xffff0000, v57
  v_pk_mul_f32 v[48:49], v[40:41], s[6:7]
  v_pk_mul_f32 v[50:51], v[42:43], s[6:7]
  v_exp_f32 v48, v48
  v_exp_f32 v49, v49
  v_exp_f32 v50, v50
  v_exp_f32 v51, v51
  v_lshlrev_b32 v44, 16, v58
  v_and_b32 v45, 0xffff0000, v58
  v_lshlrev_b32 v46, 16, v59
  v_and_b32 v47, 0xffff0000, v59
  v_pk_add_f32 v[48:49], v[48:49], 1.0 op_sel_hi:[1,0]
  v_pk_add_f32 v[50:51], v[50:51], 1.0 op_sel_hi:[1,0]
  v_rcp_f32 v48, v48
  v_rcp_f32 v49, v49
  v_rcp_f32 v50, v50
  v_rcp_f32 v51, v51
  s_nop 0
  v_pk_mul_f32 v[48:49], v[48:49], v[40:41]
  v_pk_mul_f32 v[50:51], v[50:51], v[42:43]
  v_cvt_pk_bf16_f32 v56, v48, v49
  v_cvt_pk_bf16_f32 v57, v50, v51
  v_lshlrev_b32 v48, 16, v56
  v_and_b32 v49, 0xffff0000, v56
  v_lshlrev_b32 v50, 16, v57
  v_and_b32 v51, 0xffff0000, v57
  v_pk_mul_f32 v[48:49], v[48:49], v[44:45]
  v_pk_mul_f32 v[50:51], v[50:51], v[46:47]
  v_cvt_pk_bf16_f32 v56, v48, v49
  v_cvt_pk_bf16_f32 v57, v50, v51
  ds_write_b64 v30, v[56:57] offset:0
  v_accvgpr_read_b32 v40, a68
  v_accvgpr_read_b32 v41, a69
  v_accvgpr_read_b32 v42, a70
  v_accvgpr_read_b32 v43, a71
  v_accvgpr_read_b32 v44, a100
  v_accvgpr_read_b32 v45, a101
  v_accvgpr_read_b32 v46, a102
  v_accvgpr_read_b32 v47, a103
  v_cvt_pk_bf16_f32 v56, v40, v41
  v_cvt_pk_bf16_f32 v58, v44, v45
  v_cvt_pk_bf16_f32 v57, v42, v43
  v_cvt_pk_bf16_f32 v59, v46, v47
  v_lshlrev_b32 v40, 16, v56
  v_and_b32 v41, 0xffff0000, v56
  v_lshlrev_b32 v42, 16, v57
  v_and_b32 v43, 0xffff0000, v57
  v_pk_mul_f32 v[48:49], v[40:41], s[6:7]
  v_pk_mul_f32 v[50:51], v[42:43], s[6:7]
  v_exp_f32 v48, v48
  v_exp_f32 v49, v49
  v_exp_f32 v50, v50
  v_exp_f32 v51, v51
  v_lshlrev_b32 v44, 16, v58
  v_and_b32 v45, 0xffff0000, v58
  v_lshlrev_b32 v46, 16, v59
  v_and_b32 v47, 0xffff0000, v59
  v_pk_add_f32 v[48:49], v[48:49], 1.0 op_sel_hi:[1,0]
  v_pk_add_f32 v[50:51], v[50:51], 1.0 op_sel_hi:[1,0]
  v_rcp_f32 v48, v48
  v_rcp_f32 v49, v49
  v_rcp_f32 v50, v50
  v_rcp_f32 v51, v51
  s_nop 0
  v_pk_mul_f32 v[48:49], v[48:49], v[40:41]
  v_pk_mul_f32 v[50:51], v[50:51], v[42:43]
  v_cvt_pk_bf16_f32 v56, v48, v49
  v_cvt_pk_bf16_f32 v57, v50, v51
  v_lshlrev_b32 v48, 16, v56
  v_and_b32 v49, 0xffff0000, v56
  v_lshlrev_b32 v50, 16, v57
  v_and_b32 v51, 0xffff0000, v57
  v_pk_mul_f32 v[48:49], v[48:49], v[44:45]
  v_pk_mul_f32 v[50:51], v[50:51], v[46:47]
  v_cvt_pk_bf16_f32 v56, v48, v49
  v_cvt_pk_bf16_f32 v57, v50, v51
  ds_write_b64 v30, v[56:57] offset:3584
  v_accvgpr_read_b32 v40, a72
  v_accvgpr_read_b32 v41, a73
  v_accvgpr_read_b32 v42, a74
  v_accvgpr_read_b32 v43, a75
  v_accvgpr_read_b32 v44, a104
  v_accvgpr_read_b32 v45, a105
  v_accvgpr_read_b32 v46, a106
  v_accvgpr_read_b32 v47, a107
  v_cvt_pk_bf16_f32 v56, v40, v41
  v_cvt_pk_bf16_f32 v58, v44, v45
  v_cvt_pk_bf16_f32 v57, v42, v43
  v_cvt_pk_bf16_f32 v59, v46, v47
  v_lshlrev_b32 v40, 16, v56
  v_and_b32 v41, 0xffff0000, v56
  v_lshlrev_b32 v42, 16, v57
  v_and_b32 v43, 0xffff0000, v57
  v_pk_mul_f32 v[48:49], v[40:41], s[6:7]
  v_pk_mul_f32 v[50:51], v[42:43], s[6:7]
  v_exp_f32 v48, v48
  v_exp_f32 v49, v49
  v_exp_f32 v50, v50
  v_exp_f32 v51, v51
  v_lshlrev_b32 v44, 16, v58
  v_and_b32 v45, 0xffff0000, v58
  v_lshlrev_b32 v46, 16, v59
  v_and_b32 v47, 0xffff0000, v59
  v_pk_add_f32 v[48:49], v[48:49], 1.0 op_sel_hi:[1,0]
  v_pk_add_f32 v[50:51], v[50:51], 1.0 op_sel_hi:[1,0]
  v_rcp_f32 v48, v48
  v_rcp_f32 v49, v49
  v_rcp_f32 v50, v50
  v_rcp_f32 v51, v51
  s_nop 0
  v_pk_mul_f32 v[48:49], v[48:49], v[40:41]
  v_pk_mul_f32 v[50:51], v[50:51], v[42:43]
  v_cvt_pk_bf16_f32 v56, v48, v49
  v_cvt_pk_bf16_f32 v57, v50, v51
  v_lshlrev_b32 v48, 16, v56
  v_and_b32 v49, 0xffff0000, v56
  v_lshlrev_b32 v50, 16, v57
  v_and_b32 v51, 0xffff0000, v57
  v_pk_mul_f32 v[48:49], v[48:49], v[44:45]
  v_pk_mul_f32 v[50:51], v[50:51], v[46:47]
  v_cvt_pk_bf16_f32 v56, v48, v49
  v_cvt_pk_bf16_f32 v57, v50, v51
  ds_write_b64 v30, v[56:57] offset:7168
  v_accvgpr_read_b32 v40, a76
  v_accvgpr_read_b32 v41, a77
  v_accvgpr_read_b32 v42, a78
  v_accvgpr_read_b32 v43, a79
  v_accvgpr_read_b32 v44, a108
  v_accvgpr_read_b32 v45, a109
  v_accvgpr_read_b32 v46, a110
  v_accvgpr_read_b32 v47, a111
  v_cvt_pk_bf16_f32 v56, v40, v41
  v_cvt_pk_bf16_f32 v58, v44, v45
  v_cvt_pk_bf16_f32 v57, v42, v43
  v_cvt_pk_bf16_f32 v59, v46, v47
  v_lshlrev_b32 v40, 16, v56
  v_and_b32 v41, 0xffff0000, v56
  v_lshlrev_b32 v42, 16, v57
  v_and_b32 v43, 0xffff0000, v57
  v_pk_mul_f32 v[48:49], v[40:41], s[6:7]
  v_pk_mul_f32 v[50:51], v[42:43], s[6:7]
  v_exp_f32 v48, v48
  v_exp_f32 v49, v49
  v_exp_f32 v50, v50
  v_exp_f32 v51, v51
  v_lshlrev_b32 v44, 16, v58
  v_and_b32 v45, 0xffff0000, v58
  v_lshlrev_b32 v46, 16, v59
  v_and_b32 v47, 0xffff0000, v59
  v_pk_add_f32 v[48:49], v[48:49], 1.0 op_sel_hi:[1,0]
  v_pk_add_f32 v[50:51], v[50:51], 1.0 op_sel_hi:[1,0]
  v_rcp_f32 v48, v48
  v_rcp_f32 v49, v49
  v_rcp_f32 v50, v50
  v_rcp_f32 v51, v51
  s_nop 0
  v_pk_mul_f32 v[48:49], v[48:49], v[40:41]
  v_pk_mul_f32 v[50:51], v[50:51], v[42:43]
  v_cvt_pk_bf16_f32 v56, v48, v49
  v_cvt_pk_bf16_f32 v57, v50, v51
  v_lshlrev_b32 v48, 16, v56
  v_and_b32 v49, 0xffff0000, v56
  v_lshlrev_b32 v50, 16, v57
  v_and_b32 v51, 0xffff0000, v57
  v_pk_mul_f32 v[48:49], v[48:49], v[44:45]
  v_pk_mul_f32 v[50:51], v[50:51], v[46:47]
  v_cvt_pk_bf16_f32 v56, v48, v49
  v_cvt_pk_bf16_f32 v57, v50, v51
  ds_write_b64 v30, v[56:57] offset:10752
  v_accvgpr_read_b32 v40, a80
  v_accvgpr_read_b32 v41, a81
  v_accvgpr_read_b32 v42, a82
  v_accvgpr_read_b32 v43, a83
  v_accvgpr_read_b32 v44, a112
  v_accvgpr_read_b32 v45, a113
  v_accvgpr_read_b32 v46, a114
  v_accvgpr_read_b32 v47, a115
  v_cvt_pk_bf16_f32 v56, v40, v41
  v_cvt_pk_bf16_f32 v58, v44, v45
  v_cvt_pk_bf16_f32 v57, v42, v43
  v_cvt_pk_bf16_f32 v59, v46, v47
  v_lshlrev_b32 v40, 16, v56
  v_and_b32 v41, 0xffff0000, v56
  v_lshlrev_b32 v42, 16, v57
  v_and_b32 v43, 0xffff0000, v57
  v_pk_mul_f32 v[48:49], v[40:41], s[6:7]
  v_pk_mul_f32 v[50:51], v[42:43], s[6:7]
  v_exp_f32 v48, v48
  v_exp_f32 v49, v49
  v_exp_f32 v50, v50
  v_exp_f32 v51, v51
  v_lshlrev_b32 v44, 16, v58
  v_and_b32 v45, 0xffff0000, v58
  v_lshlrev_b32 v46, 16, v59
  v_and_b32 v47, 0xffff0000, v59
  v_pk_add_f32 v[48:49], v[48:49], 1.0 op_sel_hi:[1,0]
  v_pk_add_f32 v[50:51], v[50:51], 1.0 op_sel_hi:[1,0]
  v_rcp_f32 v48, v48
  v_rcp_f32 v49, v49
  v_rcp_f32 v50, v50
  v_rcp_f32 v51, v51
  s_nop 0
  v_pk_mul_f32 v[48:49], v[48:49], v[40:41]
  v_pk_mul_f32 v[50:51], v[50:51], v[42:43]
  v_cvt_pk_bf16_f32 v56, v48, v49
  v_cvt_pk_bf16_f32 v57, v50, v51
  v_lshlrev_b32 v48, 16, v56
  v_and_b32 v49, 0xffff0000, v56
  v_lshlrev_b32 v50, 16, v57
  v_and_b32 v51, 0xffff0000, v57
  v_pk_mul_f32 v[48:49], v[48:49], v[44:45]
  v_pk_mul_f32 v[50:51], v[50:51], v[46:47]
  v_cvt_pk_bf16_f32 v56, v48, v49
  v_cvt_pk_bf16_f32 v57, v50, v51
  ds_write_b64 v30, v[56:57] offset:32
  v_accvgpr_read_b32 v40, a84
  v_accvgpr_read_b32 v41, a85
  v_accvgpr_read_b32 v42, a86
  v_accvgpr_read_b32 v43, a87
  v_accvgpr_read_b32 v44, a116
  v_accvgpr_read_b32 v45, a117
  v_accvgpr_read_b32 v46, a118
  v_accvgpr_read_b32 v47, a119
  v_cvt_pk_bf16_f32 v56, v40, v41
  v_cvt_pk_bf16_f32 v58, v44, v45
  v_cvt_pk_bf16_f32 v57, v42, v43
  v_cvt_pk_bf16_f32 v59, v46, v47
  v_lshlrev_b32 v40, 16, v56
  v_and_b32 v41, 0xffff0000, v56
  v_lshlrev_b32 v42, 16, v57
  v_and_b32 v43, 0xffff0000, v57
  v_pk_mul_f32 v[48:49], v[40:41], s[6:7]
  v_pk_mul_f32 v[50:51], v[42:43], s[6:7]
  v_exp_f32 v48, v48
  v_exp_f32 v49, v49
  v_exp_f32 v50, v50
  v_exp_f32 v51, v51
  v_lshlrev_b32 v44, 16, v58
  v_and_b32 v45, 0xffff0000, v58
  v_lshlrev_b32 v46, 16, v59
  v_and_b32 v47, 0xffff0000, v59
  v_pk_add_f32 v[48:49], v[48:49], 1.0 op_sel_hi:[1,0]
  v_pk_add_f32 v[50:51], v[50:51], 1.0 op_sel_hi:[1,0]
  v_rcp_f32 v48, v48
  v_rcp_f32 v49, v49
  v_rcp_f32 v50, v50
  v_rcp_f32 v51, v51
  s_nop 0
  v_pk_mul_f32 v[48:49], v[48:49], v[40:41]
  v_pk_mul_f32 v[50:51], v[50:51], v[42:43]
  v_cvt_pk_bf16_f32 v56, v48, v49
  v_cvt_pk_bf16_f32 v57, v50, v51
  v_lshlrev_b32 v48, 16, v56
  v_and_b32 v49, 0xffff0000, v56
  v_lshlrev_b32 v50, 16, v57
  v_and_b32 v51, 0xffff0000, v57
  v_pk_mul_f32 v[48:49], v[48:49], v[44:45]
  v_pk_mul_f32 v[50:51], v[50:51], v[46:47]
  v_cvt_pk_bf16_f32 v56, v48, v49
  v_cvt_pk_bf16_f32 v57, v50, v51
  ds_write_b64 v30, v[56:57] offset:3616
  v_accvgpr_read_b32 v40, a88
  v_accvgpr_read_b32 v41, a89
  v_accvgpr_read_b32 v42, a90
  v_accvgpr_read_b32 v43, a91
  v_accvgpr_read_b32 v44, a120
  v_accvgpr_read_b32 v45, a121
  v_accvgpr_read_b32 v46, a122
  v_accvgpr_read_b32 v47, a123
  v_cvt_pk_bf16_f32 v56, v40, v41
  v_cvt_pk_bf16_f32 v58, v44, v45
  v_cvt_pk_bf16_f32 v57, v42, v43
  v_cvt_pk_bf16_f32 v59, v46, v47
  v_lshlrev_b32 v40, 16, v56
  v_and_b32 v41, 0xffff0000, v56
  v_lshlrev_b32 v42, 16, v57
  v_and_b32 v43, 0xffff0000, v57
  v_pk_mul_f32 v[48:49], v[40:41], s[6:7]
  v_pk_mul_f32 v[50:51], v[42:43], s[6:7]
  v_exp_f32 v48, v48
  v_exp_f32 v49, v49
  v_exp_f32 v50, v50
  v_exp_f32 v51, v51
  v_lshlrev_b32 v44, 16, v58
  v_and_b32 v45, 0xffff0000, v58
  v_lshlrev_b32 v46, 16, v59
  v_and_b32 v47, 0xffff0000, v59
  v_pk_add_f32 v[48:49], v[48:49], 1.0 op_sel_hi:[1,0]
  v_pk_add_f32 v[50:51], v[50:51], 1.0 op_sel_hi:[1,0]
  v_rcp_f32 v48, v48
  v_rcp_f32 v49, v49
  v_rcp_f32 v50, v50
  v_rcp_f32 v51, v51
  s_nop 0
  v_pk_mul_f32 v[48:49], v[48:49], v[40:41]
  v_pk_mul_f32 v[50:51], v[50:51], v[42:43]
  v_cvt_pk_bf16_f32 v56, v48, v49
  v_cvt_pk_bf16_f32 v57, v50, v51
  v_lshlrev_b32 v48, 16, v56
  v_and_b32 v49, 0xffff0000, v56
  v_lshlrev_b32 v50, 16, v57
  v_and_b32 v51, 0xffff0000, v57
  v_pk_mul_f32 v[48:49], v[48:49], v[44:45]
  v_pk_mul_f32 v[50:51], v[50:51], v[46:47]
  v_cvt_pk_bf16_f32 v56, v48, v49
  v_cvt_pk_bf16_f32 v57, v50, v51
  ds_write_b64 v30, v[56:57] offset:7200
  v_accvgpr_read_b32 v40, a92
  v_accvgpr_read_b32 v41, a93
  v_accvgpr_read_b32 v42, a94
  v_accvgpr_read_b32 v43, a95
  v_accvgpr_read_b32 v44, a124
  v_accvgpr_read_b32 v45, a125
  v_accvgpr_read_b32 v46, a126
  v_accvgpr_read_b32 v47, a127
  v_cvt_pk_bf16_f32 v56, v40, v41
  v_cvt_pk_bf16_f32 v58, v44, v45
  v_cvt_pk_bf16_f32 v57, v42, v43
  v_cvt_pk_bf16_f32 v59, v46, v47
  v_lshlrev_b32 v40, 16, v56
  v_and_b32 v41, 0xffff0000, v56
  v_lshlrev_b32 v42, 16, v57
  v_and_b32 v43, 0xffff0000, v57
  v_pk_mul_f32 v[48:49], v[40:41], s[6:7]
  v_pk_mul_f32 v[50:51], v[42:43], s[6:7]
  v_exp_f32 v48, v48
  v_exp_f32 v49, v49
  v_exp_f32 v50, v50
  v_exp_f32 v51, v51
  v_lshlrev_b32 v44, 16, v58
  v_and_b32 v45, 0xffff0000, v58
  v_lshlrev_b32 v46, 16, v59
  v_and_b32 v47, 0xffff0000, v59
  v_pk_add_f32 v[48:49], v[48:49], 1.0 op_sel_hi:[1,0]
  v_pk_add_f32 v[50:51], v[50:51], 1.0 op_sel_hi:[1,0]
  v_rcp_f32 v48, v48
  v_rcp_f32 v49, v49
  v_rcp_f32 v50, v50
  v_rcp_f32 v51, v51
  s_nop 0
  v_pk_mul_f32 v[48:49], v[48:49], v[40:41]
  v_pk_mul_f32 v[50:51], v[50:51], v[42:43]
  v_cvt_pk_bf16_f32 v56, v48, v49
  v_cvt_pk_bf16_f32 v57, v50, v51
  v_lshlrev_b32 v48, 16, v56
  v_and_b32 v49, 0xffff0000, v56
  v_lshlrev_b32 v50, 16, v57
  v_and_b32 v51, 0xffff0000, v57
  v_pk_mul_f32 v[48:49], v[48:49], v[44:45]
  v_pk_mul_f32 v[50:51], v[50:51], v[46:47]
  v_cvt_pk_bf16_f32 v56, v48, v49
  v_cvt_pk_bf16_f32 v57, v50, v51
  ds_write_b64 v30, v[56:57] offset:10784
K1_e_join:
  s_waitcnt lgkmcnt(0)
  s_barrier
  s_mul_i32 s3, s52, 14336
  s_mul_i32 s4, s53, 7168
  s_add_u32 s3, s3, s4
  s_add_u32 s3, s3, 73728
  v_lshlrev_b32 v24, 4, v1
  v_add_u32 v24, s3, v24
  ds_read_b128 v[40:43], v24 offset:0
  ds_read_b128 v[44:47], v24 offset:1024
  ds_read_b128 v[48:51], v24 offset:2048
  ds_read_b128 v[52:55], v24 offset:3072
  ds_read_b128 v[56:59], v24 offset:4096
  s_lshl_b32 s3, s44, 8
  s_lshl_b32 s4, s52, 6
  s_add_u32 s3, s3, s4
  s_lshl_b32 s4, s53, 5
  s_add_u32 s3, s3, s4
  s_mul_i32 s3, s3, 7168
  s_mul_i32 s4, s45, 224
  s_add_u32 s3, s3, s4
  s_add_u32 s3, s3, 0x0
  s_movk_i32 s4, 0x1c00
  v_add_u32 v25, 0, v1
  v_mul_u32_u24 v26, 0x925, v25
  v_lshrrev_b32 v26, 15, v26
  v_mul_u32_u24 v27, 14, v26
  v_sub_u32 v25, v25, v27
  v_lshlrev_b32 v25, 4, v25
  v_mul_lo_u32 v26, s4, v26
  v_add3_u32 v25, v25, v26, s3
  s_waitcnt lgkmcnt(4)
  buffer_store_dwordx4 v[40:43], v25, s[24:27], 0 offen
  v_add_u32 v25, 64, v1
  v_mul_u32_u24 v26, 0x925, v25
  v_lshrrev_b32 v26, 15, v26
  v_mul_u32_u24 v27, 14, v26
  v_sub_u32 v25, v25, v27
  v_lshlrev_b32 v25, 4, v25
  v_mul_lo_u32 v26, s4, v26
  v_add3_u32 v25, v25, v26, s3
  s_waitcnt lgkmcnt(3)
  buffer_store_dwordx4 v[44:47], v25, s[24:27], 0 offen
  v_add_u32 v25, 128, v1
  v_mul_u32_u24 v26, 0x925, v25
  v_lshrrev_b32 v26, 15, v26
  v_mul_u32_u24 v27, 14, v26
  v_sub_u32 v25, v25, v27
  v_lshlrev_b32 v25, 4, v25
  v_mul_lo_u32 v26, s4, v26
  v_add3_u32 v25, v25, v26, s3
  s_waitcnt lgkmcnt(2)
  buffer_store_dwordx4 v[48:51], v25, s[24:27], 0 offen
  v_add_u32 v25, 192, v1
  v_mul_u32_u24 v26, 0x925, v25
  v_lshrrev_b32 v26, 15, v26
  v_mul_u32_u24 v27, 14, v26
  v_sub_u32 v25, v25, v27
  v_lshlrev_b32 v25, 4, v25
  v_mul_lo_u32 v26, s4, v26
  v_add3_u32 v25, v25, v26, s3
  s_waitcnt lgkmcnt(1)
  buffer_store_dwordx4 v[52:55], v25, s[24:27], 0 offen
  v_add_u32 v25, 256, v1
  v_mul_u32_u24 v26, 0x925, v25
  v_lshrrev_b32 v26, 15, v26
  v_mul_u32_u24 v27, 14, v26
  v_sub_u32 v25, v25, v27
  v_lshlrev_b32 v25, 4, v25
  v_mul_lo_u32 v26, s4, v26
  v_add3_u32 v25, v25, v26, s3
  s_waitcnt lgkmcnt(0)
  buffer_store_dwordx4 v[56:59], v25, s[24:27], 0 offen
  s_nop 1
  ds_read_b128 v[40:43], v24 offset:5120
  ds_read_b128 v[44:47], v24 offset:6144
  v_add_u32 v25, 320, v1
  v_mul_u32_u24 v26, 0x925, v25
  v_lshrrev_b32 v26, 15, v26
  v_mul_u32_u24 v27, 14, v26
  v_sub_u32 v25, v25, v27
  v_lshlrev_b32 v25, 4, v25
  v_mul_lo_u32 v26, s4, v26
  v_add3_u32 v25, v25, v26, s3
  s_waitcnt lgkmcnt(1)
  buffer_store_dwordx4 v[40:43], v25, s[24:27], 0 offen
  v_add_u32 v25, 384, v1
  v_mul_u32_u24 v26, 0x925, v25
  v_lshrrev_b32 v26, 15, v26
  v_mul_u32_u24 v27, 14, v26
  v_sub_u32 v25, v25, v27
  v_lshlrev_b32 v25, 4, v25
  v_mul_lo_u32 v26, s4, v26
  v_add3_u32 v25, v25, v26, s3
  s_waitcnt lgkmcnt(0)
  buffer_store_dwordx4 v[44:47], v25, s[24:27], 0 offen
  s_nop 1
  s_cmp_eq_u32 s53, 0
  s_cbranch_scc0 K1_d_skip
  s_lshl_b32 s3, 1, s44
  s_sub_u32 s3, s3, 1
  s_lshl_b32 s4, s45, 2
  v_mov_b32 v26, s4
  s_mov_b32 s5, 0
K1_poll:
  buffer_load_dword v27, v26, s[28:31], 0 offen sc1
  s_waitcnt vmcnt(0)
  v_readfirstlane_b32 s6, v27
  s_and_b32 s6, s6, s3
  s_cmp_eq_u32 s6, s3
  s_cbranch_scc1 K1_poll_done
  s_sleep 4
  s_add_u32 s5, s5, 1
  s_cmp_lt_u32 s5, 0x40000
  s_cbranch_scc1 K1_poll
K1_poll_done:
  s_lshl_b32 s4, s45, 8
  s_add_u32 s4, s4, 0x2000000
  v_and_b32 v26, 31, v0
  v_lshlrev_b32 v26, 3, v26
  v_add_u32 v26, s4, v26
  buffer_load_dwordx2 v[40:41], v26, s[24:27], 0 offen sc1
  v_add_u32 v26, 0x2000, v26
  buffer_load_dwordx2 v[42:43], v26, s[24:27], 0 offen sc1
  v_add_u32 v26, 0x2000, v26
  buffer_load_dwordx2 v[44:45], v26, s[24:27], 0 offen sc1
  v_add_u32 v26, 0x2000, v26
  buffer_load_dwordx2 v[46:47], v26, s[24:27], 0 offen sc1
  v_add_u32 v26, 0x2000, v26
  buffer_load_dwordx2 v[48:49], v26, s[24:27], 0 offen sc1
  v_add_u32 v26, 0x2000, v26
  buffer_load_dwordx2 v[50:51], v26, s[24:27], 0 offen sc1
  v_add_u32 v26, 0x2000, v26
  buffer_load_dwordx2 v[52:53], v26, s[24:27], 0 offen sc1
  v_mov_b32 v56, v62
  v_mov_b32 v57, v63
  v_mul_f32 v28, v56, v56
  v_fma_f32 v28, -v57, v57, v28
  v_mul_f32 v29, v56, v57
  v_fma_f32 v57, v57, v56, v29
  v_mov_b32 v56, v28
  v_mul_f32 v28, v56, v56
  v_fma_f32 v28, -v57, v57, v28
  v_mul_f32 v29, v56, v57
  v_fma_f32 v57, v57, v56, v29
  v_mov_b32 v56, v28
  v_mul_f32 v28, v56, v56
  v_fma_f32 v28, -v57, v57, v28
  v_mul_f32 v29, v56, v57
  v_fma_f32 v57, v57, v56, v29
  v_mov_b32 v56, v28
  v_mov_b32 v54, 0
  v_mov_b32 v55, 0
  s_waitcnt vmcnt(0)
  s_cmp_le_u32 s44, 0
  s_cbranch_scc1 K1_cin_done
  v_fma_f32 v28, v56, v54, v40
  v_fma_f32 v29, v56, v55, v41
  v_fma_f32 v28, -v57, v55, v28
  v_fma_f32 v55, v57, v54, v29
  v_mov_b32 v54, v28
  s_cmp_le_u32 s44, 1
  s_cbranch_scc1 K1_cin_done
  v_fma_f32 v28, v56, v54, v42
  v_fma_f32 v29, v56, v55, v43
  v_fma_f32 v28, -v57, v55, v28
  v_fma_f32 v55, v57, v54, v29
  v_mov_b32 v54, v28
  s_cmp_le_u32 s44, 2
  s_cbranch_scc1 K1_cin_done
  v_fma_f32 v28, v56, v54, v44
  v_fma_f32 v29, v56, v55, v45
  v_fma_f32 v28, -v57, v55, v28
  v_fma_f32 v55, v57, v54, v29
  v_mov_b32 v54, v28
  s_cmp_le_u32 s44, 3
  s_cbranch_scc1 K1_cin_done
  v_fma_f32 v28, v56, v54, v46
  v_fma_f32 v29, v56, v55, v47
  v_fma_f32 v28, -v57, v55, v28
  v_fma_f32 v55, v57, v54, v29
  v_mov_b32 v54, v28
  s_cmp_le_u32 s44, 4
  s_cbranch_scc1 K1_cin_done
  v_fma_f32 v28, v56, v54, v48
  v_fma_f32 v29, v56, v55, v49
  v_fma_f32 v28, -v57, v55, v28
  v_fma_f32 v55, v57, v54, v29
  v_mov_b32 v54, v28
  s_cmp_le_u32 s44, 5
  s_cbranch_scc1 K1_cin_done
  v_fma_f32 v28, v56, v54, v50
  v_fma_f32 v29, v56, v55, v51
  v_fma_f32 v28, -v57, v55, v28
  v_fma_f32 v55, v57, v54, v29
  v_mov_b32 v54, v28
  s_cmp_le_u32 s44, 6
  s_cbranch_scc1 K1_cin_done
  v_fma_f32 v28, v56, v54, v52
  v_fma_f32 v29, v56, v55, v53
  v_fma_f32 v28, -v57, v55, v28
  v_fma_f32 v55, v57, v54, v29
  v_mov_b32 v54, v28
K1_cin_done:
  v_fma_f32 v28, v38, v54, v36
  v_fma_f32 v29, v38, v55, v37
  v_fma_f32 v28, -v39, v55, v28
  v_fma_f32 v37, v39, v54, v29
  v_mov_b32 v36, v28
  v_lshlrev_b32 v27, 11, v31
  v_and_b32 v26, 31, v0
  v_lshlrev_b32 v26, 1, v26
  v_add_u32 v26, v26, v27
  v_fma_f32 v28, v34, v36, v94
  v_fma_f32 v29, v34, v37, v95
  v_fma_f32 v28, -v35, v37, v28
  v_fma_f32 v43, v35, v36, v29
  v_mov_b32 v42, v28
  v_mov_b32 v48, v32
  v_mov_b32 v49, v33
  v_fma_f32 v28, v48, v36, v64
  v_fma_f32 v60, v48, v42, v96
  v_mul_f32 v52, v48, v32
  v_fma_f32 v29, v48, v37, v65
  v_fma_f32 v61, v48, v43, v97
  v_mul_f32 v53, v48, v33
  v_fma_f32 v28, -v49, v37, v28
  v_fma_f32 v60, -v49, v43, v60
  v_fma_f32 v52, -v49, v33, v52
  v_fma_f32 v65, v49, v36, v29
  v_fma_f32 v97, v49, v42, v61
  v_fma_f32 v53, v49, v32, v53
  v_mov_b32 v64, v28
  v_mov_b32 v96, v60
  v_cvt_pk_bf16_f32 v64, v64, -v65
  v_cvt_pk_bf16_f32 v96, v96, -v97
  ds_write_b16 v26, v64 offset:4096
  ds_write_b16 v26, v96 offset:5120
  ds_write_b16_d16_hi v26, v64 offset:20480
  ds_write_b16_d16_hi v26, v96 offset:21504
  v_fma_f32 v28, v52, v36, v66
  v_fma_f32 v60, v52, v42, v98
  v_mul_f32 v48, v52, v32
  v_fma_f32 v29, v52, v37, v67
  v_fma_f32 v61, v52, v43, v99
  v_mul_f32 v49, v52, v33
  v_fma_f32 v28, -v53, v37, v28
  v_fma_f32 v60, -v53, v43, v60
  v_fma_f32 v48, -v53, v33, v48
  v_fma_f32 v67, v53, v36, v29
  v_fma_f32 v99, v53, v42, v61
  v_fma_f32 v49, v53, v32, v49
  v_mov_b32 v66, v28
  v_mov_b32 v98, v60
  v_cvt_pk_bf16_f32 v66, v66, -v67
  v_cvt_pk_bf16_f32 v98, v98, -v99
  ds_write_b16 v26, v66 offset:4160
  ds_write_b16 v26, v98 offset:5184
  ds_write_b16_d16_hi v26, v66 offset:20544
  ds_write_b16_d16_hi v26, v98 offset:21568
  v_fma_f32 v28, v48, v36, v68
  v_fma_f32 v60, v48, v42, v100
  v_mul_f32 v52, v48, v32
  v_fma_f32 v29, v48, v37, v69
  v_fma_f32 v61, v48, v43, v101
  v_mul_f32 v53, v48, v33
  v_fma_f32 v28, -v49, v37, v28
  v_fma_f32 v60, -v49, v43, v60
  v_fma_f32 v52, -v49, v33, v52
  v_fma_f32 v69, v49, v36, v29
  v_fma_f32 v101, v49, v42, v61
  v_fma_f32 v53, v49, v32, v53
  v_mov_b32 v68, v28
  v_mov_b32 v100, v60
  v_cvt_pk_bf16_f32 v68, v68, -v69
  v_cvt_pk_bf16_f32 v100, v100, -v101
  ds_write_b16 v26, v68 offset:4224
  ds_write_b16 v26, v100 offset:5248
  ds_write_b16_d16_hi v26, v68 offset:20608
  ds_write_b16_d16_hi v26, v100 offset:21632
  v_fma_f32 v28, v52, v36, v70
  v_fma_f32 v60, v52, v42, v102
  v_mul_f32 v48, v52, v32
  v_fma_f32 v29, v52, v37, v71
  v_fma_f32 v61, v52, v43, v103
  v_mul_f32 v49, v52, v33
  v_fma_f32 v28, -v53, v37, v28
  v_fma_f32 v60, -v53, v43, v60
  v_fma_f32 v48, -v53, v33, v48
  v_fma_f32 v71, v53, v36, v29
  v_fma_f32 v103, v53, v42, v61
  v_fma_f32 v49, v53, v32, v49
  v_mov_b32 v70, v28
  v_mov_b32 v102, v60
  v_cvt_pk_bf16_f32 v70, v70, -v71
  v_cvt_pk_bf16_f32 v102, v102, -v103
  ds_write_b16 v26, v70 offset:4288
  ds_write_b16 v26, v102 offset:5312
  ds_write_b16_d16_hi v26, v70 offset:20672
  ds_write_b16_d16_hi v26, v102 offset:21696
  v_fma_f32 v28, v48, v36, v72
  v_fma_f32 v60, v48, v42, v104
  v_mul_f32 v52, v48, v32
  v_fma_f32 v29, v48, v37, v73
  v_fma_f32 v61, v48, v43, v105
  v_mul_f32 v53, v48, v33
  v_fma_f32 v28, -v49, v37, v28
  v_fma_f32 v60, -v49, v43, v60
  v_fma_f32 v52, -v49, v33, v52
  v_fma_f32 v73, v49, v36, v29
  v_fma_f32 v105, v49, v42, v61
  v_fma_f32 v53, v49, v32, v53
  v_mov_b32 v72, v28
  v_mov_b32 v104, v60
  v_cvt_pk_bf16_f32 v72, v72, -v73
  v_cvt_pk_bf16_f32 v104, v104, -v105
  ds_write_b16 v26, v72 offset:4352
  ds_write_b16 v26, v104 offset:5376
  ds_write_b16_d16_hi v26, v72 offset:20736
  ds_write_b16_d16_hi v26, v104 offset:21760
  v_fma_f32 v28, v52, v36, v74
  v_fma_f32 v60, v52, v42, v106
  v_mul_f32 v48, v52, v32
  v_fma_f32 v29, v52, v37, v75
  v_fma_f32 v61, v52, v43, v107
  v_mul_f32 v49, v52, v33
  v_fma_f32 v28, -v53, v37, v28
  v_fma_f32 v60, -v53, v43, v60
  v_fma_f32 v48, -v53, v33, v48
  v_fma_f32 v75, v53, v36, v29
  v_fma_f32 v107, v53, v42, v61
  v_fma_f32 v49, v53, v32, v49
  v_mov_b32 v74, v28
  v_mov_b32 v106, v60
  v_cvt_pk_bf16_f32 v74, v74, -v75
  v_cvt_pk_bf16_f32 v106, v106, -v107
  ds_write_b16 v26, v74 offset:4416
  ds_write_b16 v26, v106 offset:5440
  ds_write_b16_d16_hi v26, v74 offset:20800
  ds_write_b16_d16_hi v26, v106 offset:21824
  v_fma_f32 v28, v48, v36, v76
  v_fma_f32 v60, v48, v42, v108
  v_mul_f32 v52, v48, v32
  v_fma_f32 v29, v48, v37, v77
  v_fma_f32 v61, v48, v43, v109
  v_mul_f32 v53, v48, v33
  v_fma_f32 v28, -v49, v37, v28
  v_fma_f32 v60, -v49, v43, v60
  v_fma_f32 v52, -v49, v33, v52
  v_fma_f32 v77, v49, v36, v29
  v_fma_f32 v109, v49, v42, v61
  v_fma_f32 v53, v49, v32, v53
  v_mov_b32 v76, v28
  v_mov_b32 v108, v60
  v_cvt_pk_bf16_f32 v76, v76, -v77
  v_cvt_pk_bf16_f32 v108, v108, -v109
  ds_write_b16 v26, v76 offset:4480
  ds_write_b16 v26, v108 offset:5504
  ds_write_b16_d16_hi v26, v76 offset:20864
  ds_write_b16_d16_hi v26, v108 offset:21888
  v_fma_f32 v28, v52, v36, v78
  v_fma_f32 v60, v52, v42, v110
  v_mul_f32 v48, v52, v32
  v_fma_f32 v29, v52, v37, v79
  v_fma_f32 v61, v52, v43, v111
  v_mul_f32 v49, v52, v33
  v_fma_f32 v28, -v53, v37, v28
  v_fma_f32 v60, -v53, v43, v60
  v_fma_f32 v48, -v53, v33, v48
  v_fma_f32 v79, v53, v36, v29
  v_fma_f32 v111, v53, v42, v61
  v_fma_f32 v49, v53, v32, v49
  v_mov_b32 v78, v28
  v_mov_b32 v110, v60
  v_cvt_pk_bf16_f32 v78, v78, -v79
  v_cvt_pk_bf16_f32 v110, v110, -v111
  ds_write_b16 v26, v78 offset:4544
  ds_write_b16 v26, v110 offset:5568
  ds_write_b16_d16_hi v26, v78 offset:20928
  ds_write_b16_d16_hi v26, v110 offset:21952
  v_fma_f32 v28, v48, v36, v80
  v_fma_f32 v60, v48, v42, v112
  v_mul_f32 v52, v48, v32
  v_fma_f32 v29, v48, v37, v81
  v_fma_f32 v61, v48, v43, v113
  v_mul_f32 v53, v48, v33
  v_fma_f32 v28, -v49, v37, v28
  v_fma_f32 v60, -v49, v43, v60
  v_fma_f32 v52, -v49, v33, v52
  v_fma_f32 v81, v49, v36, v29
  v_fma_f32 v113, v49, v42, v61
  v_fma_f32 v53, v49, v32, v53
  v_mov_b32 v80, v28
  v_mov_b32 v112, v60
  v_cvt_pk_bf16_f32 v80, v80, -v81
  v_cvt_pk_bf16_f32 v112, v112, -v113
  ds_write_b16 v26, v80 offset:4608
  ds_write_b16 v26, v112 offset:5632
  ds_write_b16_d16_hi v26, v80 offset:20992
  ds_write_b16_d16_hi v26, v112 offset:22016
  v_fma_f32 v28, v52, v36, v82
  v_fma_f32 v60, v52, v42, v114
  v_mul_f32 v48, v52, v32
  v_fma_f32 v29, v52, v37, v83
  v_fma_f32 v61, v52, v43, v115
  v_mul_f32 v49, v52, v33
  v_fma_f32 v28, -v53, v37, v28
  v_fma_f32 v60, -v53, v43, v60
  v_fma_f32 v48, -v53, v33, v48
  v_fma_f32 v83, v53, v36, v29
  v_fma_f32 v115, v53, v42, v61
  v_fma_f32 v49, v53, v32, v49
  v_mov_b32 v82, v28
  v_mov_b32 v114, v60
  v_cvt_pk_bf16_f32 v82, v82, -v83
  v_cvt_pk_bf16_f32 v114, v114, -v115
  ds_write_b16 v26, v82 offset:4672
  ds_write_b16 v26, v114 offset:5696
  ds_write_b16_d16_hi v26, v82 offset:21056
  ds_write_b16_d16_hi v26, v114 offset:22080
  v_fma_f32 v28, v48, v36, v84
  v_fma_f32 v60, v48, v42, v116
  v_mul_f32 v52, v48, v32
  v_fma_f32 v29, v48, v37, v85
  v_fma_f32 v61, v48, v43, v117
  v_mul_f32 v53, v48, v33
  v_fma_f32 v28, -v49, v37, v28
  v_fma_f32 v60, -v49, v43, v60
  v_fma_f32 v52, -v49, v33, v52
  v_fma_f32 v85, v49, v36, v29
  v_fma_f32 v117, v49, v42, v61
  v_fma_f32 v53, v49, v32, v53
  v_mov_b32 v84, v28
  v_mov_b32 v116, v60
  v_cvt_pk_bf16_f32 v84, v84, -v85
  v_cvt_pk_bf16_f32 v116, v116, -v117
  ds_write_b16 v26, v84 offset:4736
  ds_write_b16 v26, v116 offset:5760
  ds_write_b16_d16_hi v26, v84 offset:21120
  ds_write_b16_d16_hi v26, v116 offset:22144
  v_fma_f32 v28, v52, v36, v86
  v_fma_f32 v60, v52, v42, v118
  v_mul_f32 v48, v52, v32
  v_fma_f32 v29, v52, v37, v87
  v_fma_f32 v61, v52, v43, v119
  v_mul_f32 v49, v52, v33
  v_fma_f32 v28, -v53, v37, v28
  v_fma_f32 v60, -v53, v43, v60
  v_fma_f32 v48, -v53, v33, v48
  v_fma_f32 v87, v53, v36, v29
  v_fma_f32 v119, v53, v42, v61
  v_fma_f32 v49, v53, v32, v49
  v_mov_b32 v86, v28
  v_mov_b32 v118, v60
  v_cvt_pk_bf16_f32 v86, v86, -v87
  v_cvt_pk_bf16_f32 v118, v118, -v119
  ds_write_b16 v26, v86 offset:4800
  ds_write_b16 v26, v118 offset:5824
  ds_write_b16_d16_hi v26, v86 offset:21184
  ds_write_b16_d16_hi v26, v118 offset:22208
  v_fma_f32 v28, v48, v36, v88
  v_fma_f32 v60, v48, v42, v120
  v_mul_f32 v52, v48, v32
  v_fma_f32 v29, v48, v37, v89
  v_fma_f32 v61, v48, v43, v121
  v_mul_f32 v53, v48, v33
  v_fma_f32 v28, -v49, v37, v28
  v_fma_f32 v60, -v49, v43, v60
  v_fma_f32 v52, -v49, v33, v52
  v_fma_f32 v89, v49, v36, v29
  v_fma_f32 v121, v49, v42, v61
  v_fma_f32 v53, v49, v32, v53
  v_mov_b32 v88, v28
  v_mov_b32 v120, v60
  v_cvt_pk_bf16_f32 v88, v88, -v89
  v_cvt_pk_bf16_f32 v120, v120, -v121
  ds_write_b16 v26, v88 offset:4864
  ds_write_b16 v26, v120 offset:5888
  ds_write_b16_d16_hi v26, v88 offset:21248
  ds_write_b16_d16_hi v26, v120 offset:22272
  v_fma_f32 v28, v52, v36, v90
  v_fma_f32 v60, v52, v42, v122
  v_mul_f32 v48, v52, v32
  v_fma_f32 v29, v52, v37, v91
  v_fma_f32 v61, v52, v43, v123
  v_mul_f32 v49, v52, v33
  v_fma_f32 v28, -v53, v37, v28
  v_fma_f32 v60, -v53, v43, v60
  v_fma_f32 v48, -v53, v33, v48
  v_fma_f32 v91, v53, v36, v29
  v_fma_f32 v123, v53, v42, v61
  v_fma_f32 v49, v53, v32, v49
  v_mov_b32 v90, v28
  v_mov_b32 v122, v60
  v_cvt_pk_bf16_f32 v90, v90, -v91
  v_cvt_pk_bf16_f32 v122, v122, -v123
  ds_write_b16 v26, v90 offset:4928
  ds_write_b16 v26, v122 offset:5952
  ds_write_b16_d16_hi v26, v90 offset:21312
  ds_write_b16_d16_hi v26, v122 offset:22336
  v_fma_f32 v28, v48, v36, v92
  v_fma_f32 v60, v48, v42, v124
  v_mul_f32 v52, v48, v32
  v_fma_f32 v29, v48, v37, v93
  v_fma_f32 v61, v48, v43, v125
  v_mul_f32 v53, v48, v33
  v_fma_f32 v28, -v49, v37, v28
  v_fma_f32 v60, -v49, v43, v60
  v_fma_f32 v52, -v49, v33, v52
  v_fma_f32 v93, v49, v36, v29
  v_fma_f32 v125, v49, v42, v61
  v_fma_f32 v53, v49, v32, v53
  v_mov_b32 v92, v28
  v_mov_b32 v124, v60
  v_cvt_pk_bf16_f32 v92, v92, -v93
  v_cvt_pk_bf16_f32 v124, v124, -v125
  ds_write_b16 v26, v92 offset:4992
  ds_write_b16 v26, v124 offset:6016
  ds_write_b16_d16_hi v26, v92 offset:21376
  ds_write_b16_d16_hi v26, v124 offset:22400
  v_fma_f32 v28, v52, v36, v94
  v_fma_f32 v60, v52, v42, v126
  v_fma_f32 v29, v52, v37, v95
  v_fma_f32 v61, v52, v43, v127
  v_fma_f32 v28, -v53, v37, v28
  v_fma_f32 v60, -v53, v43, v60
  v_fma_f32 v95, v53, v36, v29
  v_fma_f32 v127, v53, v42, v61
  v_mov_b32 v94, v28
  v_mov_b32 v126, v60
  v_cvt_pk_bf16_f32 v94, v94, -v95
  v_cvt_pk_bf16_f32 v126, v126, -v127
  ds_write_b16 v26, v94 offset:5056
  ds_write_b16 v26, v126 offset:6080
  ds_write_b16_d16_hi v26, v94 offset:21440
  ds_write_b16_d16_hi v26, v126 offset:22464
K1_d_skip:
  s_waitcnt lgkmcnt(0)
  s_barrier
  s_lshl_b32 s3, s43, 11
  v_lshlrev_b32 v26, 4, v1
  v_add_u32 v26, s3, v26
  ds_read_b128 v[40:43], v26 offset:4096
  ds_read_b128 v[44:47], v26 offset:5120
  ds_read_b128 v[48:51], v26 offset:20480
  ds_read_b128 v[52:55], v26 offset:21504
  s_lshl_b32 s3, s44, 8
  s_lshl_b32 s4, s43, 5
  s_add_u32 s3, s3, s4
  s_lshl_b32 s3, s3, 12
  s_lshl_b32 s4, s45, 6
  s_add_u32 s3, s3, s4
  s_add_u32 s3, s3, 0x2100000
  v_lshrrev_b32 v27, 2, v1
  v_lshlrev_b32 v27, 12, v27
  v_and_b32 v26, 3, v1
  v_lshlrev_b32 v26, 4, v26
  v_add3_u32 v26, v26, v27, s3
  v_add_u32 v27, 0x10000, v26
  s_waitcnt lgkmcnt(3)
  buffer_store_dwordx4 v[40:43], v26, s[24:27], 0 offen offset:0
  s_waitcnt lgkmcnt(2)
  buffer_store_dwordx4 v[44:47], v27, s[24:27], 0 offen offset:0
  s_waitcnt lgkmcnt(1)
  buffer_store_dwordx4 v[48:51], v26, s[24:27], 0 offen offset:2048
  s_waitcnt lgkmcnt(0)
  buffer_store_dwordx4 v[52:55], v27, s[24:27], 0 offen offset:2048
K1_done:
  s_endpgm
.globl k3_kernel
.p2align 8
.type k3_kernel,@function
k3_kernel:
  s_cmp_ge_u32 s2, 256
  s_cbranch_scc1 K3_done
  s_load_dwordx16 s[64:79], s[0:1], 0
  s_load_dwordx16 s[80:95], s[0:1], 64
  s_load_dwordx2 s[96:97], s[0:1], 128
  v_lshrrev_b32 v1, 6, v0
  s_nop 0
  v_readfirstlane_b32 s32, v1
  s_and_b32 s3, s2, 7
  s_lshr_b32 s4, s2, 3
  s_and_b32 s35, s4, 1
  s_lshr_b32 s5, s4, 1
  s_and_b32 s5, s5, 3
  s_lshr_b32 s6, s3, 1
  s_lshl_b32 s6, s6, 2
  s_add_u32 s33, s5, s6
  s_lshr_b32 s5, s4, 3
  s_and_b32 s6, s3, 1
  s_lshl_b32 s6, s6, 2
  s_add_u32 s34, s5, s6
  s_lshl_b32 s43, s33, 3
  s_add_u32 s43, s43, s34
  s_lshr_b32 s36, s32, 1
  s_and_b32 s52, s32, 1
  v_and_b32 v1, 63, v0
  s_waitcnt lgkmcnt(0)
  s_mov_b32 s8, s96
  s_and_b32 s9, s97, 0xffff
  s_mov_b32 s10, 0x10000000
  s_mov_b32 s11, 0x00020000
  s_mov_b32 s16, s88
  s_and_b32 s17, s89, 0xffff
  s_mov_b32 s18, 0x700000
  s_mov_b32 s19, 0x00020000
  s_mov_b32 s20, s64
  s_and_b32 s21, s65, 0xffff
  s_mov_b32 s22, 0x400000
  s_mov_b32 s23, 0x00020000
  s_mov_b32 s24, s92
  s_and_b32 s25, s93, 0xffff
  s_mov_b32 s26, 0x800000
  s_mov_b32 s27, 0x00020000
  s_mov_b32 s28, s80
  s_and_b32 s29, s81, 0xffff
  s_mov_b32 s30, 0x800
  s_mov_b32 s31, 0x00020000
  s_mov_b32 s48, s94
  s_and_b32 s49, s95, 0xffff
  s_mov_b32 s50, 0x100
  s_mov_b32 s51, 0x00020000
  s_mov_b32 s12, s74
  s_and_b32 s13, s75, 0xffff
  s_mov_b32 s14, 0x200000
  s_mov_b32 s15, 0x00020000
  v_lshrrev_b32 v24, 4, v1
  v_and_b32 v25, 7, v1
  v_xor_b32 v24, v24, v25
  v_lshlrev_b32 v24, 4, v24
  v_and_b32 v25, 15, v1
  v_lshlrev_b32 v25, 7, v25
  v_add_u32 v24, v24, v25
  v_xor_b32 v25, 64, v24
  s_lshl_b32 s3, s36, 13
  s_lshl_b32 s4, s52, 13
  s_add_u32 s4, s4, 0x4000
  v_add_u32 v10, s3, v24
  v_add_u32 v12, s4, v24
  v_add_u32 v11, s3, v25
  v_add_u32 v13, s4, v25
  v_lshrrev_b32 v24, 4, v1
  v_lshlrev_b32 v24, 2, v24
  v_and_b32 v25, 15, v1
  v_lshrrev_b32 v25, 2, v25
  v_add_u32 v24, v24, v25
  v_and_b32 v25, 7, v24
  v_lshlrev_b32 v24, 8, v24
  v_and_b32 v26, 3, v1
  v_lshlrev_b32 v26, 3, v26
  v_add_u32 v24, v24, v26
  v_add_u32 v24, 0x4000, v24
  s_lshl_b32 s3, s52, 2
  s_add_u32 s4, s3, 0
  v_xor_b32 v26, s4, v25
  v_lshlrev_b32 v26, 5, v26
  v_add_u32 v14, v24, v26
  s_add_u32 s4, s3, 1
  v_xor_b32 v26, s4, v25
  v_lshlrev_b32 v26, 5, v26
  v_add_u32 v15, v24, v26
  s_add_u32 s4, s3, 2
  v_xor_b32 v26, s4, v25
  v_lshlrev_b32 v26, 5, v26
  v_add_u32 v16, v24, v26
  s_add_u32 s4, s3, 3
  v_xor_b32 v26, s4, v25
  v_lshlrev_b32 v26, 5, v26
  v_add_u32 v17, v24, v26
  v_accvgpr_write_b32 a0, 0
  v_accvgpr_write_b32 a1, 0
  v_accvgpr_write_b32 a2, 0
  v_accvgpr_write_b32 a3, 0
  v_accvgpr_write_b32 a4, 0
  v_accvgpr_write_b32 a5, 0
  v_accvgpr_write_b32 a6, 0
  v_accvgpr_write_b32 a7, 0
  v_accvgpr_write_b32 a8, 0
  v_accvgpr_write_b32 a9, 0
  v_accvgpr_write_b32 a10, 0
  v_accvgpr_write_b32 a11, 0
  v_accvgpr_write_b32 a12, 0
  v_accvgpr_write_b32 a13, 0
  v_accvgpr_write_b32 a14, 0
  v_accvgpr_write_b32 a15, 0
  v_accvgpr_write_b32 a16, 0
  v_accvgpr_write_b32 a17, 0
  v_accvgpr_write_b32 a18, 0
  v_accvgpr_write_b32 a19, 0
  v_accvgpr_write_b32 a20, 0
  v_accvgpr_write_b32 a21, 0
  v_accvgpr_write_b32 a22, 0
  v_accvgpr_write_b32 a23, 0
  v_accvgpr_write_b32 a24, 0
  v_accvgpr_write_b32 a25, 0
  v_accvgpr_write_b32 a26, 0
  v_accvgpr_write_b32 a27, 0
  v_accvgpr_write_b32 a28, 0
  v_accvgpr_write_b32 a29, 0
  v_accvgpr_write_b32 a30, 0
  v_accvgpr_write_b32 a31, 0
  v_accvgpr_write_b32 a32, 0
  v_accvgpr_write_b32 a33, 0
  v_accvgpr_write_b32 a34, 0
  v_accvgpr_write_b32 a35, 0
  v_accvgpr_write_b32 a36, 0
  v_accvgpr_write_b32 a37, 0
  v_accvgpr_write_b32 a38, 0
  v_accvgpr_write_b32 a39, 0
  v_accvgpr_write_b32 a40, 0
  v_accvgpr_write_b32 a41, 0
  v_accvgpr_write_b32 a42, 0
  v_accvgpr_write_b32 a43, 0
  v_accvgpr_write_b32 a44, 0
  v_accvgpr_write_b32 a45, 0
  v_accvgpr_write_b32 a46, 0
  v_accvgpr_write_b32 a47, 0
  v_accvgpr_write_b32 a48, 0
  v_accvgpr_write_b32 a49, 0
  v_accvgpr_write_b32 a50, 0
  v_accvgpr_write_b32 a51, 0
  v_accvgpr_write_b32 a52, 0
  v_accvgpr_write_b32 a53, 0
  v_accvgpr_write_b32 a54, 0
  v_accvgpr_write_b32 a55, 0
  v_accvgpr_write_b32 a56, 0
  v_accvgpr_write_b32 a57, 0
  v_accvgpr_write_b32 a58, 0
  v_accvgpr_write_b32 a59, 0
  v_accvgpr_write_b32 a60, 0
  v_accvgpr_write_b32 a61, 0
  v_accvgpr_write_b32 a62, 0
  v_accvgpr_write_b32 a63, 0
  v_accvgpr_write_b32 a64, 0
  v_accvgpr_write_b32 a65, 0
  v_accvgpr_write_b32 a66, 0
  v_accvgpr_write_b32 a67, 0
  v_accvgpr_write_b32 a68, 0
  v_accvgpr_write_b32 a69, 0
  v_accvgpr_write_b32 a70, 0
  v_accvgpr_write_b32 a71, 0
  v_accvgpr_write_b32 a72, 0
  v_accvgpr_write_b32 a73, 0
  v_accvgpr_write_b32 a74, 0
  v_accvgpr_write_b32 a75, 0
  v_accvgpr_write_b32 a76, 0
  v_accvgpr_write_b32 a77, 0
  v_accvgpr_write_b32 a78, 0
  v_accvgpr_write_b32 a79, 0
  v_accvgpr_write_b32 a80, 0
  v_accvgpr_write_b32 a81, 0
  v_accvgpr_write_b32 a82, 0
  v_accvgpr_write_b32 a83, 0
  v_accvgpr_write_b32 a84, 0
  v_accvgpr_write_b32 a85, 0
  v_accvgpr_write_b32 a86, 0
  v_accvgpr_write_b32 a87, 0
  v_accvgpr_write_b32 a88, 0
  v_accvgpr_write_b32 a89, 0
  v_accvgpr_write_b32 a90, 0
  v_accvgpr_write_b32 a91, 0
  v_accvgpr_write_b32 a92, 0
  v_accvgpr_write_b32 a93, 0
  v_accvgpr_write_b32 a94, 0
  v_accvgpr_write_b32 a95, 0
  v_accvgpr_write_b32 a96, 0
  v_accvgpr_write_b32 a97, 0
  v_accvgpr_write_b32 a98, 0
  v_accvgpr_write_b32 a99, 0
  v_accvgpr_write_b32 a100, 0
  v_accvgpr_write_b32 a101, 0
  v_accvgpr_write_b32 a102, 0
  v_accvgpr_write_b32 a103, 0
  v_accvgpr_write_b32 a104, 0
  v_accvgpr_write_b32 a105, 0
  v_accvgpr_write_b32 a106, 0
  v_accvgpr_write_b32 a107, 0
  v_accvgpr_write_b32 a108, 0
  v_accvgpr_write_b32 a109, 0
  v_accvgpr_write_b32 a110, 0
  v_accvgpr_write_b32 a111, 0
  v_accvgpr_write_b32 a112, 0
  v_accvgpr_write_b32 a113, 0
  v_accvgpr_write_b32 a114, 0
  v_accvgpr_write_b32 a115, 0
  v_accvgpr_write_b32 a116, 0
  v_accvgpr_write_b32 a117, 0
  v_accvgpr_write_b32 a118, 0
  v_accvgpr_write_b32 a119, 0
  v_accvgpr_write_b32 a120, 0
  v_accvgpr_write_b32 a121, 0
  v_accvgpr_write_b32 a122, 0
  v_accvgpr_write_b32 a123, 0
  v_accvgpr_write_b32 a124, 0
  v_accvgpr_write_b32 a125, 0
  v_accvgpr_write_b32 a126, 0
  v_accvgpr_write_b32 a127, 0
  s_lshl_b32 s3, s43, 16
  s_lshl_b32 s4, s32, 14
  s_add_u32 s3, s3, s4
  s_add_u32 s3, s3, 0x4000000
  v_lshlrev_b32 v32, 4, v1
  v_add_u32 v32, s3, v32
  s_cmp_eq_u32 s35, 0
  s_cbranch_scc1 K3_role0
  s_mov_b32 s37, 44
  s_mov_b32 s38, 12
  v_lshrrev_b32 v25, 3, v1
  v_and_b32 v24, 7, v1
  v_xor_b32 v24, v24, v25
  v_lshlrev_b32 v24, 4, v24
  s_mov_b32 s44, 7168
  v_mul_lo_u32 v25, s44, v25
  v_add_u32 v24, v24, v25
  s_lshl_b32 s3, s33, 2
  s_add_u32 s3, s3, s32
  s_mul_i32 s3, s3, 0x38000
  s_add_u32 s3, s3, 0x0
  s_add_u32 s4, s3, 0x0
  v_add_u32 v2, s4, v24
  s_add_u32 s4, s3, 0xdc00
  v_add_u32 v3, s4, v24
  s_add_u32 s4, s3, 0x1b800
  v_add_u32 v4, s4, v24
  s_add_u32 s4, s3, 0x29400
  v_add_u32 v5, s4, v24
  s_lshr_b32 s3, s32, 1
  s_lshl_b32 s3, s3, 5
  s_and_b32 s4, s32, 1
  s_lshl_b32 s4, s4, 2
  s_add_u32 s3, s3, s4
  s_lshl_b32 s3, s3, 11
  s_lshl_b32 s4, s34, 8
  s_add_u32 s3, s3, s4
  v_lshrrev_b32 v24, 4, v1
  v_add_u32 v25, 0, v24
  v_lshrrev_b32 v26, 1, v1
  v_and_b32 v26, 7, v26
  v_xor_b32 v25, v25, v26
  v_lshlrev_b32 v25, 5, v25
  v_and_b32 v26, 1, v1
  v_lshlrev_b32 v26, 4, v26
  v_lshlrev_b32 v24, 11, v24
  v_add3_u32 v24, v24, v25, v26
  s_add_u32 s4, s3, 0
  v_add_u32 v6, s4, v24
  v_lshrrev_b32 v24, 4, v1
  v_add_u32 v25, 4, v24
  v_lshrrev_b32 v26, 1, v1
  v_and_b32 v26, 7, v26
  v_xor_b32 v25, v25, v26
  v_lshlrev_b32 v25, 5, v25
  v_and_b32 v26, 1, v1
  v_lshlrev_b32 v26, 4, v26
  v_lshlrev_b32 v24, 11, v24
  v_add3_u32 v24, v24, v25, v26
  s_add_u32 s4, s3, 15360
  v_add_u32 v7, s4, v24
  v_lshrrev_b32 v24, 4, v1
  v_add_u32 v25, 0, v24
  v_lshrrev_b32 v26, 1, v1
  v_and_b32 v26, 7, v26
  v_xor_b32 v25, v25, v26
  v_lshlrev_b32 v25, 5, v25
  v_and_b32 v26, 1, v1
  v_lshlrev_b32 v26, 4, v26
  v_lshlrev_b32 v24, 11, v24
  v_add3_u32 v24, v24, v25, v26
  s_add_u32 s4, s3, 30720
  v_add_u32 v8, s4, v24
  v_lshrrev_b32 v24, 4, v1
  v_add_u32 v25, 4, v24
  v_lshrrev_b32 v26, 1, v1
  v_and_b32 v26, 7, v26
  v_xor_b32 v25, v25, v26
  v_lshlrev_b32 v25, 5, v25
  v_and_b32 v26, 1, v1
  v_lshlrev_b32 v26, 4, v26
  v_lshlrev_b32 v24, 11, v24
  v_add3_u32 v24, v24, v25, v26
  s_add_u32 s4, s3, 46080
  v_add_u32 v9, s4, v24
  s_sub_u32 s38, s38, 1
  s_mov_b32 s41, 0
  s_mov_b32 s42, 0
  s_add_u32 s38, s38, 1
  s_lshl_b32 s39, s38, 7
  s_lshl_b32 s40, s38, 17
  s_add_u32 s42, s42, 32768
  s_and_b32 s42, s42, 131071
  s_mov_b32 s42, 0
  s_lshl_b32 s44, s32, 12
  s_add_u32 s44, s44, s42
  s_add_u32 m0, s44, 0
  s_nop 0
  buffer_load_dwordx4 v2, s[8:11], s39 offen offset:0 lds
  buffer_load_dwordx4 v3, s[8:11], s39 offen offset:1024 lds
  buffer_load_dwordx4 v4, s[8:11], s39 offen offset:2048 lds
  buffer_load_dwordx4 v5, s[8:11], s39 offen offset:3072 lds
  s_lshl_b32 s44, s32, 12
  s_add_u32 s44, s44, s42
  s_add_u32 m0, s44, 16384
  s_nop 0
  buffer_load_dwordx4 v6, s[16:19], s40 offen offset:0 lds
  buffer_load_dwordx4 v7, s[16:19], s40 offen offset:1024 lds
  buffer_load_dwordx4 v8, s[16:19], s40 offen offset:2048 lds
  buffer_load_dwordx4 v9, s[16:19], s40 offen offset:3072 lds
  s_add_u32 s38, s38, 1
  s_lshl_b32 s39, s38, 7
  s_lshl_b32 s40, s38, 17
  s_add_u32 s42, s42, 32768
  s_and_b32 s42, s42, 131071
  s_lshl_b32 s44, s32, 12
  s_add_u32 s44, s44, s42
  s_add_u32 m0, s44, 0
  s_nop 0
  buffer_load_dwordx4 v2, s[8:11], s39 offen offset:0 lds
  buffer_load_dwordx4 v3, s[8:11], s39 offen offset:1024 lds
  buffer_load_dwordx4 v4, s[8:11], s39 offen offset:2048 lds
  buffer_load_dwordx4 v5, s[8:11], s39 offen offset:3072 lds
  s_lshl_b32 s44, s32, 12
  s_add_u32 s44, s44, s42
  s_add_u32 m0, s44, 16384
  s_nop 0
  buffer_load_dwordx4 v6, s[16:19], s40 offen offset:0 lds
  buffer_load_dwordx4 v7, s[16:19], s40 offen offset:1024 lds
  buffer_load_dwordx4 v8, s[16:19], s40 offen offset:2048 lds
  buffer_load_dwordx4 v9, s[16:19], s40 offen offset:3072 lds
  s_add_u32 s38, s38, 1
  s_lshl_b32 s39, s38, 7
  s_lshl_b32 s40, s38, 17
  s_add_u32 s42, s42, 32768
  s_and_b32 s42, s42, 131071
  s_lshl_b32 s44, s32, 12
  s_add_u32 s44, s44, s42
  s_add_u32 m0, s44, 0
  s_nop 0
  buffer_load_dwordx4 v2, s[8:11], s39 offen offset:0 lds
  buffer_load_dwordx4 v3, s[8:11], s39 offen offset:1024 lds
  buffer_load_dwordx4 v4, s[8:11], s39 offen offset:2048 lds
  buffer_load_dwordx4 v5, s[8:11], s39 offen offset:3072 lds
  s_lshl_b32 s44, s32, 12
  s_add_u32 s44, s44, s42
  s_add_u32 m0, s44, 16384
  s_nop 0
  buffer_load_dwordx4 v6, s[16:19], s40 offen offset:0 lds
  buffer_load_dwordx4 v7, s[16:19], s40 offen offset:1024 lds
  buffer_load_dwordx4 v8, s[16:19], s40 offen offset:2048 lds
  buffer_load_dwordx4 v9, s[16:19], s40 offen offset:3072 lds
  s_add_u32 s38, s38, 1
  s_lshl_b32 s39, s38, 7
  s_lshl_b32 s40, s38, 17
  s_add_u32 s42, s42, 32768
  s_and_b32 s42, s42, 131071
  s_lshl_b32 s44, s32, 12
  s_add_u32 s44, s44, s42
  s_add_u32 m0, s44, 0
  s_nop 0
  buffer_load_dwordx4 v2, s[8:11], s39 offen offset:0 lds
  buffer_load_dwordx4 v3, s[8:11], s39 offen offset:1024 lds
  buffer_load_dwordx4 v4, s[8:11], s39 offen offset:2048 lds
  buffer_load_dwordx4 v5, s[8:11], s39 offen offset:3072 lds
  s_lshl_b32 s44, s32, 12
  s_add_u32 s44, s44, s42
  s_add_u32 m0, s44, 16384
  s_nop 0
  buffer_load_dwordx4 v6, s[16:19], s40 offen offset:0 lds
  buffer_load_dwordx4 v7, s[16:19], s40 offen offset:1024 lds
  buffer_load_dwordx4 v8, s[16:19], s40 offen offset:2048 lds
  buffer_load_dwordx4 v9, s[16:19], s40 offen offset:3072 lds
  s_add_u32 s38, s38, 1
  s_lshl_b32 s39, s38, 7
  s_lshl_b32 s40, s38, 17
  s_add_u32 s42, s42, 32768
  s_and_b32 s42, s42, 131071
  s_waitcnt vmcnt(24)
  s_barrier
  v_add_u32 v18, s41, v10
  v_add_u32 v19, s41, v11
  v_add_u32 v20, s41, v14
  v_add_u32 v21, s41, v15
  v_add_u32 v22, s41, v16
  v_add_u32 v23, s41, v17
  ds_read_b64_tr_b16 v[104:105], v20 offset:0
  ds_read_b64_tr_b16 v[106:107], v20 offset:4096
  ds_read_b64_tr_b16 v[108:109], v21 offset:0
  ds_read_b64_tr_b16 v[110:111], v21 offset:4096
  ds_read_b64_tr_b16 v[112:113], v22 offset:0
  ds_read_b64_tr_b16 v[114:115], v22 offset:4096
  ds_read_b64_tr_b16 v[116:117], v23 offset:0
  ds_read_b64_tr_b16 v[118:119], v23 offset:4096
  ds_read_b128 v[40:43], v18 offset:0
  ds_read_b128 v[44:47], v18 offset:2048
  ds_read_b128 v[48:51], v18 offset:4096
  ds_read_b128 v[52:55], v18 offset:6144
  ds_read_b64_tr_b16 v[120:121], v20 offset:8192
  ds_read_b64_tr_b16 v[122:123], v20 offset:12288
  ds_read_b64_tr_b16 v[124:125], v21 offset:8192
  ds_read_b64_tr_b16 v[126:127], v21 offset:12288
  ds_read_b64_tr_b16 v[128:129], v22 offset:8192
  ds_read_b64_tr_b16 v[130:131], v22 offset:12288
  ds_read_b64_tr_b16 v[132:133], v23 offset:8192
  ds_read_b64_tr_b16 v[134:135], v23 offset:12288
  ds_read_b128 v[56:59], v19 offset:0
  ds_read_b128 v[60:63], v19 offset:2048
  ds_read_b128 v[64:67], v19 offset:4096
  ds_read_b128 v[68:71], v19 offset:6144
  s_add_u32 s41, s41, 32768
  s_and_b32 s41, s41, 131071
K3_seg1_1_loop:
  s_waitcnt vmcnt(16) lgkmcnt(0)
  s_barrier
  v_add_u32 v18, s41, v10
  v_add_u32 v19, s41, v11
  v_add_u32 v20, s41, v14
  v_add_u32 v21, s41, v15
  v_add_u32 v22, s41, v16
  v_add_u32 v23, s41, v17
  ds_read_b64_tr_b16 v[136:137], v20 offset:0
  v_mfma_f32_16x16x32_bf16 a[64:67], v[104:107], v[40:43], a[64:67]
  ds_read_b64_tr_b16 v[138:139], v20 offset:4096
  v_mfma_f32_16x16x32_bf16 a[68:71], v[104:107], v[44:47], a[68:71]
  ds_read_b64_tr_b16 v[140:141], v21 offset:0
  v_mfma_f32_16x16x32_bf16 a[72:75], v[104:107], v[48:51], a[72:75]
  ds_read_b64_tr_b16 v[142:143], v21 offset:4096
  v_mfma_f32_16x16x32_bf16 a[76:79], v[104:107], v[52:55], a[76:79]
  ds_read_b64_tr_b16 v[144:145], v22 offset:0
  s_lshl_b32 s44, s32, 12
  s_add_u32 s44, s44, s42
  s_add_u32 m0, s44, 0
  s_nop 0
  buffer_load_dwordx4 v2, s[8:11], s39 offen offset:0 lds
  v_mfma_f32_16x16x32_bf16 a[80:83], v[108:111], v[40:43], a[80:83]
  ds_read_b64_tr_b16 v[146:147], v22 offset:4096
  v_mfma_f32_16x16x32_bf16 a[84:87], v[108:111], v[44:47], a[84:87]
  ds_read_b64_tr_b16 v[148:149], v23 offset:0
  buffer_load_dwordx4 v3, s[8:11], s39 offen offset:1024 lds
  v_mfma_f32_16x16x32_bf16 a[88:91], v[108:111], v[48:51], a[88:91]
  ds_read_b64_tr_b16 v[150:151], v23 offset:4096
  v_mfma_f32_16x16x32_bf16 a[92:95], v[108:111], v[52:55], a[92:95]
  ds_read_b128 v[72:75], v18 offset:0
  buffer_load_dwordx4 v4, s[8:11], s39 offen offset:2048 lds
  v_mfma_f32_16x16x32_bf16 a[96:99], v[112:115], v[40:43], a[96:99]
  ds_read_b128 v[76:79], v18 offset:2048
  v_mfma_f32_16x16x32_bf16 a[100:103], v[112:115], v[44:47], a[100:103]
  ds_read_b128 v[80:83], v18 offset:4096
  buffer_load_dwordx4 v5, s[8:11], s39 offen offset:3072 lds
  v_mfma_f32_16x16x32_bf16 a[104:107], v[112:115], v[48:51], a[104:107]
  ds_read_b128 v[84:87], v18 offset:6144
  v_mfma_f32_16x16x32_bf16 a[108:111], v[112:115], v[52:55], a[108:111]
  ds_read_b64_tr_b16 v[152:153], v20 offset:8192
  s_lshl_b32 s44, s32, 12
  s_add_u32 s44, s44, s42
  s_add_u32 m0, s44, 16384
  s_nop 0
  buffer_load_dwordx4 v6, s[16:19], s40 offen offset:0 lds
  v_mfma_f32_16x16x32_bf16 a[112:115], v[116:119], v[40:43], a[112:115]
  ds_read_b64_tr_b16 v[154:155], v20 offset:12288
  v_mfma_f32_16x16x32_bf16 a[116:119], v[116:119], v[44:47], a[116:119]
  ds_read_b64_tr_b16 v[156:157], v21 offset:8192
  buffer_load_dwordx4 v7, s[16:19], s40 offen offset:1024 lds
  v_mfma_f32_16x16x32_bf16 a[120:123], v[116:119], v[48:51], a[120:123]
  ds_read_b64_tr_b16 v[158:159], v21 offset:12288
  v_mfma_f32_16x16x32_bf16 a[124:127], v[116:119], v[52:55], a[124:127]
  ds_read_b64_tr_b16 v[160:161], v22 offset:8192
  buffer_load_dwordx4 v8, s[16:19], s40 offen offset:2048 lds
  v_mfma_f32_16x16x32_bf16 a[64:67], v[120:123], v[56:59], a[64:67]
  ds_read_b64_tr_b16 v[162:163], v22 offset:12288
  v_mfma_f32_16x16x32_bf16 a[68:71], v[120:123], v[60:63], a[68:71]
  ds_read_b64_tr_b16 v[164:165], v23 offset:8192
  buffer_load_dwordx4 v9, s[16:19], s40 offen offset:3072 lds
  v_mfma_f32_16x16x32_bf16 a[72:75], v[120:123], v[64:67], a[72:75]
  ds_read_b64_tr_b16 v[166:167], v23 offset:12288
  v_mfma_f32_16x16x32_bf16 a[76:79], v[120:123], v[68:71], a[76:79]
  ds_read_b128 v[88:91], v19 offset:0
  v_mfma_f32_16x16x32_bf16 a[80:83], v[124:127], v[56:59], a[80:83]
  ds_read_b128 v[92:95], v19 offset:2048
  v_mfma_f32_16x16x32_bf16 a[84:87], v[124:127], v[60:63], a[84:87]
  ds_read_b128 v[96:99], v19 offset:4096
  v_mfma_f32_16x16x32_bf16 a[88:91], v[124:127], v[64:67], a[88:91]
  ds_read_b128 v[100:103], v19 offset:6144
  v_mfma_f32_16x16x32_bf16 a[92:95], v[124:127], v[68:71], a[92:95]
  v_mfma_f32_16x16x32_bf16 a[96:99], v[128:131], v[56:59], a[96:99]
  v_mfma_f32_16x16x32_bf16 a[100:103], v[128:131], v[60:63], a[100:103]
  v_mfma_f32_16x16x32_bf16 a[104:107], v[128:131], v[64:67], a[104:107]
  v_mfma_f32_16x16x32_bf16 a[108:111], v[128:131], v[68:71], a[108:111]
  v_mfma_f32_16x16x32_bf16 a[112:115], v[132:135], v[56:59], a[112:115]
  v_mfma_f32_16x16x32_bf16 a[116:119], v[132:135], v[60:63], a[116:119]
  v_mfma_f32_16x16x32_bf16 a[120:123], v[132:135], v[64:67], a[120:123]
  v_mfma_f32_16x16x32_bf16 a[124:127], v[132:135], v[68:71], a[124:127]
  s_add_u32 s38, s38, 1
  s_lshl_b32 s39, s38, 7
  s_lshl_b32 s40, s38, 17
  s_add_u32 s42, s42, 32768
  s_and_b32 s42, s42, 131071
  s_add_u32 s41, s41, 32768
  s_and_b32 s41, s41, 131071
  s_waitcnt vmcnt(16) lgkmcnt(0)
  s_barrier
  v_add_u32 v18, s41, v10
  v_add_u32 v19, s41, v11
  v_add_u32 v20, s41, v14
  v_add_u32 v21, s41, v15
  v_add_u32 v22, s41, v16
  v_add_u32 v23, s41, v17
  ds_read_b64_tr_b16 v[104:105], v20 offset:0
  v_mfma_f32_16x16x32_bf16 a[64:67], v[136:139], v[72:75], a[64:67]
  ds_read_b64_tr_b16 v[106:107], v20 offset:4096
  v_mfma_f32_16x16x32_bf16 a[68:71], v[136:139], v[76:79], a[68:71]
  ds_read_b64_tr_b16 v[108:109], v21 offset:0
  v_mfma_f32_16x16x32_bf16 a[72:75], v[136:139], v[80:83], a[72:75]
  ds_read_b64_tr_b16 v[110:111], v21 offset:4096
  v_mfma_f32_16x16x32_bf16 a[76:79], v[136:139], v[84:87], a[76:79]
  ds_read_b64_tr_b16 v[112:113], v22 offset:0
  s_lshl_b32 s44, s32, 12
  s_add_u32 s44, s44, s42
  s_add_u32 m0, s44, 0
  s_nop 0
  buffer_load_dwordx4 v2, s[8:11], s39 offen offset:0 lds
  v_mfma_f32_16x16x32_bf16 a[80:83], v[140:143], v[72:75], a[80:83]
  ds_read_b64_tr_b16 v[114:115], v22 offset:4096
  v_mfma_f32_16x16x32_bf16 a[84:87], v[140:143], v[76:79], a[84:87]
  ds_read_b64_tr_b16 v[116:117], v23 offset:0
  buffer_load_dwordx4 v3, s[8:11], s39 offen offset:1024 lds
  v_mfma_f32_16x16x32_bf16 a[88:91], v[140:143], v[80:83], a[88:91]
  ds_read_b64_tr_b16 v[118:119], v23 offset:4096
  v_mfma_f32_16x16x32_bf16 a[92:95], v[140:143], v[84:87], a[92:95]
  ds_read_b128 v[40:43], v18 offset:0
  buffer_load_dwordx4 v4, s[8:11], s39 offen offset:2048 lds
  v_mfma_f32_16x16x32_bf16 a[96:99], v[144:147], v[72:75], a[96:99]
  ds_read_b128 v[44:47], v18 offset:2048
  v_mfma_f32_16x16x32_bf16 a[100:103], v[144:147], v[76:79], a[100:103]
  ds_read_b128 v[48:51], v18 offset:4096
  buffer_load_dwordx4 v5, s[8:11], s39 offen offset:3072 lds
  v_mfma_f32_16x16x32_bf16 a[104:107], v[144:147], v[80:83], a[104:107]
  ds_read_b128 v[52:55], v18 offset:6144
  v_mfma_f32_16x16x32_bf16 a[108:111], v[144:147], v[84:87], a[108:111]
  ds_read_b64_tr_b16 v[120:121], v20 offset:8192
  s_lshl_b32 s44, s32, 12
  s_add_u32 s44, s44, s42
  s_add_u32 m0, s44, 16384
  s_nop 0
  buffer_load_dwordx4 v6, s[16:19], s40 offen offset:0 lds
  v_mfma_f32_16x16x32_bf16 a[112:115], v[148:151], v[72:75], a[112:115]
  ds_read_b64_tr_b16 v[122:123], v20 offset:12288
  v_mfma_f32_16x16x32_bf16 a[116:119], v[148:151], v[76:79], a[116:119]
  ds_read_b64_tr_b16 v[124:125], v21 offset:8192
  buffer_load_dwordx4 v7, s[16:19], s40 offen offset:1024 lds
  v_mfma_f32_16x16x32_bf16 a[120:123], v[148:151], v[80:83], a[120:123]
  ds_read_b64_tr_b16 v[126:127], v21 offset:12288
  v_mfma_f32_16x16x32_bf16 a[124:127], v[148:151], v[84:87], a[124:127]
  ds_read_b64_tr_b16 v[128:129], v22 offset:8192
  buffer_load_dwordx4 v8, s[16:19], s40 offen offset:2048 lds
  v_mfma_f32_16x16x32_bf16 a[64:67], v[152:155], v[88:91], a[64:67]
  ds_read_b64_tr_b16 v[130:131], v22 offset:12288
  v_mfma_f32_16x16x32_bf16 a[68:71], v[152:155], v[92:95], a[68:71]
  ds_read_b64_tr_b16 v[132:133], v23 offset:8192
  buffer_load_dwordx4 v9, s[16:19], s40 offen offset:3072 lds
  v_mfma_f32_16x16x32_bf16 a[72:75], v[152:155], v[96:99], a[72:75]
  ds_read_b64_tr_b16 v[134:135], v23 offset:12288
  v_mfma_f32_16x16x32_bf16 a[76:79], v[152:155], v[100:103], a[76:79]
  ds_read_b128 v[56:59], v19 offset:0
  v_mfma_f32_16x16x32_bf16 a[80:83], v[156:159], v[88:91], a[80:83]
  ds_read_b128 v[60:63], v19 offset:2048
  v_mfma_f32_16x16x32_bf16 a[84:87], v[156:159], v[92:95], a[84:87]
  ds_read_b128 v[64:67], v19 offset:4096
  v_mfma_f32_16x16x32_bf16 a[88:91], v[156:159], v[96:99], a[88:91]
  ds_read_b128 v[68:71], v19 offset:6144
  v_mfma_f32_16x16x32_bf16 a[92:95], v[156:159], v[100:103], a[92:95]
  v_mfma_f32_16x16x32_bf16 a[96:99], v[160:163], v[88:91], a[96:99]
  v_mfma_f32_16x16x32_bf16 a[100:103], v[160:163], v[92:95], a[100:103]
  v_mfma_f32_16x16x32_bf16 a[104:107], v[160:163], v[96:99], a[104:107]
  v_mfma_f32_16x16x32_bf16 a[108:111], v[160:163], v[100:103], a[108:111]
  v_mfma_f32_16x16x32_bf16 a[112:115], v[164:167], v[88:91], a[112:115]
  v_mfma_f32_16x16x32_bf16 a[116:119], v[164:167], v[92:95], a[116:119]
  v_mfma_f32_16x16x32_bf16 a[120:123], v[164:167], v[96:99], a[120:123]
  v_mfma_f32_16x16x32_bf16 a[124:127], v[164:167], v[100:103], a[124:127]
  s_add_u32 s38, s38, 1
  s_lshl_b32 s39, s38, 7
  s_lshl_b32 s40, s38, 17
  s_add_u32 s42, s42, 32768
  s_and_b32 s42, s42, 131071
  s_add_u32 s41, s41, 32768
  s_and_b32 s41, s41, 131071
  s_sub_u32 s37, s37, 2
  s_cmp_gt_u32 s37, 0
  s_cbranch_scc1 K3_seg1_1_loop
  s_waitcnt vmcnt(0)
  s_waitcnt lgkmcnt(0)
  s_barrier
  s_nop 7
  v_accvgpr_read_b32 v40, a64
  v_accvgpr_read_b32 v41, a65
  v_accvgpr_read_b32 v42, a66
  v_accvgpr_read_b32 v43, a67
  v_accvgpr_read_b32 v44, a68
  v_accvgpr_read_b32 v45, a69
  v_accvgpr_read_b32 v46, a70
  v_accvgpr_read_b32 v47, a71
  v_accvgpr_read_b32 v48, a72
  v_accvgpr_read_b32 v49, a73
  v_accvgpr_read_b32 v50, a74
  v_accvgpr_read_b32 v51, a75
  v_accvgpr_read_b32 v52, a76
  v_accvgpr_read_b32 v53, a77
  v_accvgpr_read_b32 v54, a78
  v_accvgpr_read_b32 v55, a79
  buffer_store_dwordx4 v[40:43], v32, s[8:11], 0 offen offset:0 sc1
  buffer_store_dwordx4 v[44:47], v32, s[8:11], 0 offen offset:1024 sc1
  buffer_store_dwordx4 v[48:51], v32, s[8:11], 0 offen offset:2048 sc1
  buffer_store_dwordx4 v[52:55], v32, s[8:11], 0 offen offset:3072 sc1
  v_add_u32 v32, 0x1000, v32
  v_accvgpr_read_b32 v56, a80
  v_accvgpr_read_b32 v57, a81
  v_accvgpr_read_b32 v58, a82
  v_accvgpr_read_b32 v59, a83
  v_accvgpr_read_b32 v60, a84
  v_accvgpr_read_b32 v61, a85
  v_accvgpr_read_b32 v62, a86
  v_accvgpr_read_b32 v63, a87
  v_accvgpr_read_b32 v64, a88
  v_accvgpr_read_b32 v65, a89
  v_accvgpr_read_b32 v66, a90
  v_accvgpr_read_b32 v67, a91
  v_accvgpr_read_b32 v68, a92
  v_accvgpr_read_b32 v69, a93
  v_accvgpr_read_b32 v70, a94
  v_accvgpr_read_b32 v71, a95
  buffer_store_dwordx4 v[56:59], v32, s[8:11], 0 offen offset:0 sc1
  buffer_store_dwordx4 v[60:63], v32, s[8:11], 0 offen offset:1024 sc1
  buffer_store_dwordx4 v[64:67], v32, s[8:11], 0 offen offset:2048 sc1
  buffer_store_dwordx4 v[68:71], v32, s[8:11], 0 offen offset:3072 sc1
  v_add_u32 v32, 0x1000, v32
  v_accvgpr_read_b32 v72, a96
  v_accvgpr_read_b32 v73, a97
  v_accvgpr_read_b32 v74, a98
  v_accvgpr_read_b32 v75, a99
  v_accvgpr_read_b32 v76, a100
  v_accvgpr_read_b32 v77, a101
  v_accvgpr_read_b32 v78, a102
  v_accvgpr_read_b32 v79, a103
  v_accvgpr_read_b32 v80, a104
  v_accvgpr_read_b32 v81, a105
  v_accvgpr_read_b32 v82, a106
  v_accvgpr_read_b32 v83, a107
  v_accvgpr_read_b32 v84, a108
  v_accvgpr_read_b32 v85, a109
  v_accvgpr_read_b32 v86, a110
  v_accvgpr_read_b32 v87, a111
  buffer_store_dwordx4 v[72:75], v32, s[8:11], 0 offen offset:0 sc1
  buffer_store_dwordx4 v[76:79], v32, s[8:11], 0 offen offset:1024 sc1
  buffer_store_dwordx4 v[80:83], v32, s[8:11], 0 offen offset:2048 sc1
  buffer_store_dwordx4 v[84:87], v32, s[8:11], 0 offen offset:3072 sc1
  v_add_u32 v32, 0x1000, v32
  v_accvgpr_read_b32 v88, a112
  v_accvgpr_read_b32 v89, a113
  v_accvgpr_read_b32 v90, a114
  v_accvgpr_read_b32 v91, a115
  v_accvgpr_read_b32 v92, a116
  v_accvgpr_read_b32 v93, a117
  v_accvgpr_read_b32 v94, a118
  v_accvgpr_read_b32 v95, a119
  v_accvgpr_read_b32 v96, a120
  v_accvgpr_read_b32 v97, a121
  v_accvgpr_read_b32 v98, a122
  v_accvgpr_read_b32 v99, a123
  v_accvgpr_read_b32 v100, a124
  v_accvgpr_read_b32 v101, a125
  v_accvgpr_read_b32 v102, a126
  v_accvgpr_read_b32 v103, a127
  buffer_store_dwordx4 v[88:91], v32, s[8:11], 0 offen offset:0 sc1
  buffer_store_dwordx4 v[92:95], v32, s[8:11], 0 offen offset:1024 sc1
  buffer_store_dwordx4 v[96:99], v32, s[8:11], 0 offen offset:2048 sc1
  buffer_store_dwordx4 v[100:103], v32, s[8:11], 0 offen offset:3072 sc1
  v_add_u32 v32, 0x1000, v32
  s_waitcnt vmcnt(0)
  s_barrier
  s_cmp_lg_u32 s32, 0
  s_cbranch_scc1 K3_done
  s_and_b32 s3, s43, 31
  s_lshl_b32 s3, 1, s3
  v_mov_b32 v24, s3
  s_lshr_b32 s3, s43, 5
  s_lshl_b32 s3, s3, 2
  v_mov_b32 v25, s3
  v_cmp_eq_u32 vcc, 0, v0
  s_and_saveexec_b64 s[4:5], vcc
  buffer_atomic_or v24, v25, s[48:51], 0 offen sc1
  s_endpgm
K3_role0:
  s_mov_b32 s37, 32
  s_mov_b32 s38, 0
  v_lshrrev_b32 v25, 3, v1
  v_and_b32 v24, 7, v1
  v_xor_b32 v24, v24, v25
  v_lshlrev_b32 v24, 4, v24
  s_mov_b32 s44, 4096
  v_mul_lo_u32 v25, s44, v25
  v_add_u32 v24, v24, v25
  s_lshl_b32 s3, s33, 2
  s_add_u32 s3, s3, s32
  s_mul_i32 s3, s3, 0x20000
  s_add_u32 s3, s3, 0x2100000
  s_add_u32 s4, s3, 0x0
  v_add_u32 v2, s4, v24
  s_add_u32 s4, s3, 0x7c00
  v_add_u32 v3, s4, v24
  s_add_u32 s4, s3, 0xf800
  v_add_u32 v4, s4, v24
  s_add_u32 s4, s3, 0x17400
  v_add_u32 v5, s4, v24
  v_lshrrev_b32 v25, 3, v1
  v_and_b32 v24, 7, v1
  v_xor_b32 v24, v24, v25
  v_lshlrev_b32 v24, 4, v24
  s_mov_b32 s44, 2048
  v_mul_lo_u32 v25, s44, v25
  v_add_u32 v24, v24, v25
  s_lshl_b32 s3, s34, 2
  s_add_u32 s3, s3, s32
  s_lshl_b32 s3, s3, 16
  s_add_u32 s4, s3, 0x0
  v_add_u32 v6, s4, v24
  s_add_u32 s4, s3, 0x3c00
  v_add_u32 v7, s4, v24
  s_add_u32 s4, s3, 0x7800
  v_add_u32 v8, s4, v24
  s_add_u32 s4, s3, 0xb400
  v_add_u32 v9, s4, v24
  s_sub_u32 s38, s38, 1
  s_mov_b32 s41, 0
  s_mov_b32 s42, 0
  s_add_u32 s38, s38, 1
  s_lshl_b32 s39, s38, 7
  s_and_b32 s40, s38, 15
  s_lshl_b32 s40, s40, 7
  s_cmp_lt_u32 s38, 16
  s_cselect_b32 s12, s74, s76
  s_cselect_b32 s13, s75, s77
  s_and_b32 s13, s13, 0xffff
  s_add_u32 s42, s42, 32768
  s_and_b32 s42, s42, 131071
  s_mov_b32 s42, 0
  s_lshl_b32 s44, s32, 12
  s_add_u32 s44, s44, s42
  s_add_u32 m0, s44, 0
  s_nop 0
  buffer_load_dwordx4 v2, s[8:11], s39 offen offset:0 lds
  buffer_load_dwordx4 v3, s[8:11], s39 offen offset:1024 lds
  buffer_load_dwordx4 v4, s[8:11], s39 offen offset:2048 lds
  buffer_load_dwordx4 v5, s[8:11], s39 offen offset:3072 lds
  s_lshl_b32 s44, s32, 12
  s_add_u32 s44, s44, s42
  s_add_u32 m0, s44, 16384
  s_nop 0
  buffer_load_dwordx4 v6, s[12:15], s40 offen offset:0 lds
  buffer_load_dwordx4 v7, s[12:15], s40 offen offset:1024 lds
  buffer_load_dwordx4 v8, s[12:15], s40 offen offset:2048 lds
  buffer_load_dwordx4 v9, s[12:15], s40 offen offset:3072 lds
  s_add_u32 s38, s38, 1
  s_lshl_b32 s39, s38, 7
  s_and_b32 s40, s38, 15
  s_lshl_b32 s40, s40, 7
  s_cmp_lt_u32 s38, 16
  s_cselect_b32 s12, s74, s76
  s_cselect_b32 s13, s75, s77
  s_and_b32 s13, s13, 0xffff
  s_add_u32 s42, s42, 32768
  s_and_b32 s42, s42, 131071
  s_lshl_b32 s44, s32, 12
  s_add_u32 s44, s44, s42
  s_add_u32 m0, s44, 0
  s_nop 0
  buffer_load_dwordx4 v2, s[8:11], s39 offen offset:0 lds
  buffer_load_dwordx4 v3, s[8:11], s39 offen offset:1024 lds
  buffer_load_dwordx4 v4, s[8:11], s39 offen offset:2048 lds
  buffer_load_dwordx4 v5, s[8:11], s39 offen offset:3072 lds
  s_lshl_b32 s44, s32, 12
  s_add_u32 s44, s44, s42
  s_add_u32 m0, s44, 16384
  s_nop 0
  buffer_load_dwordx4 v6, s[12:15], s40 offen offset:0 lds
  buffer_load_dwordx4 v7, s[12:15], s40 offen offset:1024 lds
  buffer_load_dwordx4 v8, s[12:15], s40 offen offset:2048 lds
  buffer_load_dwordx4 v9, s[12:15], s40 offen offset:3072 lds
  s_add_u32 s38, s38, 1
  s_lshl_b32 s39, s38, 7
  s_and_b32 s40, s38, 15
  s_lshl_b32 s40, s40, 7
  s_cmp_lt_u32 s38, 16
  s_cselect_b32 s12, s74, s76
  s_cselect_b32 s13, s75, s77
  s_and_b32 s13, s13, 0xffff
  s_add_u32 s42, s42, 32768
  s_and_b32 s42, s42, 131071
  s_lshl_b32 s44, s32, 12
  s_add_u32 s44, s44, s42
  s_add_u32 m0, s44, 0
  s_nop 0
  buffer_load_dwordx4 v2, s[8:11], s39 offen offset:0 lds
  buffer_load_dwordx4 v3, s[8:11], s39 offen offset:1024 lds
  buffer_load_dwordx4 v4, s[8:11], s39 offen offset:2048 lds
  buffer_load_dwordx4 v5, s[8:11], s39 offen offset:3072 lds
  s_lshl_b32 s44, s32, 12
  s_add_u32 s44, s44, s42
  s_add_u32 m0, s44, 16384
  s_nop 0
  buffer_load_dwordx4 v6, s[12:15], s40 offen offset:0 lds
  buffer_load_dwordx4 v7, s[12:15], s40 offen offset:1024 lds
  buffer_load_dwordx4 v8, s[12:15], s40 offen offset:2048 lds
  buffer_load_dwordx4 v9, s[12:15], s40 offen offset:3072 lds
  s_add_u32 s38, s38, 1
  s_lshl_b32 s39, s38, 7
  s_and_b32 s40, s38, 15
  s_lshl_b32 s40, s40, 7
  s_cmp_lt_u32 s38, 16
  s_cselect_b32 s12, s74, s76
  s_cselect_b32 s13, s75, s77
  s_and_b32 s13, s13, 0xffff
  s_add_u32 s42, s42, 32768
  s_and_b32 s42, s42, 131071
  s_lshl_b32 s44, s32, 12
  s_add_u32 s44, s44, s42
  s_add_u32 m0, s44, 0
  s_nop 0
  buffer_load_dwordx4 v2, s[8:11], s39 offen offset:0 lds
  buffer_load_dwordx4 v3, s[8:11], s39 offen offset:1024 lds
  buffer_load_dwordx4 v4, s[8:11], s39 offen offset:2048 lds
  buffer_load_dwordx4 v5, s[8:11], s39 offen offset:3072 lds
  s_lshl_b32 s44, s32, 12
  s_add_u32 s44, s44, s42
  s_add_u32 m0, s44, 16384
  s_nop 0
  buffer_load_dwordx4 v6, s[12:15], s40 offen offset:0 lds
  buffer_load_dwordx4 v7, s[12:15], s40 offen offset:1024 lds
  buffer_load_dwordx4 v8, s[12:15], s40 offen offset:2048 lds
  buffer_load_dwordx4 v9, s[12:15], s40 offen offset:3072 lds
  s_add_u32 s38, s38, 1
  s_lshl_b32 s39, s38, 7
  s_and_b32 s40, s38, 15
  s_lshl_b32 s40, s40, 7
  s_cmp_lt_u32 s38, 16
  s_cselect_b32 s12, s74, s76
  s_cselect_b32 s13, s75, s77
  s_and_b32 s13, s13, 0xffff
  s_add_u32 s42, s42, 32768
  s_and_b32 s42, s42, 131071
  s_waitcnt vmcnt(24)
  s_barrier
  v_add_u32 v18, s41, v10
  v_add_u32 v19, s41, v11
  v_add_u32 v20, s41, v12
  v_add_u32 v21, s41, v13
  ds_read_b128 v[104:107], v20 offset:0
  ds_read_b128 v[108:111], v20 offset:2048
  ds_read_b128 v[112:115], v20 offset:4096
  ds_read_b128 v[116:119], v20 offset:6144
  ds_read_b128 v[40:43], v18 offset:0
  ds_read_b128 v[44:47], v18 offset:2048
  ds_read_b128 v[48:51], v18 offset:4096
  ds_read_b128 v[52:55], v18 offset:6144
  ds_read_b128 v[120:123], v21 offset:0
  ds_read_b128 v[124:127], v21 offset:2048
  ds_read_b128 v[128:131], v21 offset:4096
  ds_read_b128 v[132:135], v21 offset:6144
  ds_read_b128 v[56:59], v19 offset:0
  ds_read_b128 v[60:63], v19 offset:2048
  ds_read_b128 v[64:67], v19 offset:4096
  ds_read_b128 v[68:71], v19 offset:6144
  s_add_u32 s41, s41, 32768
  s_and_b32 s41, s41, 131071
K3_seg0_2_loop:
  s_waitcnt vmcnt(16) lgkmcnt(0)
  s_barrier
  v_add_u32 v18, s41, v10
  v_add_u32 v19, s41, v11
  v_add_u32 v20, s41, v12
  v_add_u32 v21, s41, v13
  ds_read_b128 v[136:139], v20 offset:0
  v_mfma_f32_16x16x32_bf16 a[0:3], v[104:107], v[40:43], a[0:3]
  ds_read_b128 v[140:143], v20 offset:2048
  v_mfma_f32_16x16x32_bf16 a[4:7], v[104:107], v[44:47], a[4:7]
  ds_read_b128 v[144:147], v20 offset:4096
  v_mfma_f32_16x16x32_bf16 a[8:11], v[104:107], v[48:51], a[8:11]
  ds_read_b128 v[148:151], v20 offset:6144
  v_mfma_f32_16x16x32_bf16 a[12:15], v[104:107], v[52:55], a[12:15]
  ds_read_b128 v[72:75], v18 offset:0
  s_lshl_b32 s44, s32, 12
  s_add_u32 s44, s44, s42
  s_add_u32 m0, s44, 0
  s_nop 0
  buffer_load_dwordx4 v2, s[8:11], s39 offen offset:0 lds
  v_mfma_f32_16x16x32_bf16 a[16:19], v[108:111], v[40:43], a[16:19]
  ds_read_b128 v[76:79], v18 offset:2048
  v_mfma_f32_16x16x32_bf16 a[20:23], v[108:111], v[44:47], a[20:23]
  ds_read_b128 v[80:83], v18 offset:4096
  buffer_load_dwordx4 v3, s[8:11], s39 offen offset:1024 lds
  v_mfma_f32_16x16x32_bf16 a[24:27], v[108:111], v[48:51], a[24:27]
  ds_read_b128 v[84:87], v18 offset:6144
  v_mfma_f32_16x16x32_bf16 a[28:31], v[108:111], v[52:55], a[28:31]
  ds_read_b128 v[152:155], v21 offset:0
  buffer_load_dwordx4 v4, s[8:11], s39 offen offset:2048 lds
  v_mfma_f32_16x16x32_bf16 a[32:35], v[112:115], v[40:43], a[32:35]
  ds_read_b128 v[156:159], v21 offset:2048
  v_mfma_f32_16x16x32_bf16 a[36:39], v[112:115], v[44:47], a[36:39]
  ds_read_b128 v[160:163], v21 offset:4096
  buffer_load_dwordx4 v5, s[8:11], s39 offen offset:3072 lds
  v_mfma_f32_16x16x32_bf16 a[40:43], v[112:115], v[48:51], a[40:43]
  ds_read_b128 v[164:167], v21 offset:6144
  v_mfma_f32_16x16x32_bf16 a[44:47], v[112:115], v[52:55], a[44:47]
  ds_read_b128 v[88:91], v19 offset:0
  s_lshl_b32 s44, s32, 12
  s_add_u32 s44, s44, s42
  s_add_u32 m0, s44, 16384
  s_nop 0
  buffer_load_dwordx4 v6, s[12:15], s40 offen offset:0 lds
  v_mfma_f32_16x16x32_bf16 a[48:51], v[116:119], v[40:43], a[48:51]
  ds_read_b128 v[92:95], v19 offset:2048
  v_mfma_f32_16x16x32_bf16 a[52:55], v[116:119], v[44:47], a[52:55]
  ds_read_b128 v[96:99], v19 offset:4096
  buffer_load_dwordx4 v7, s[12:15], s40 offen offset:1024 lds
  v_mfma_f32_16x16x32_bf16 a[56:59], v[116:119], v[48:51], a[56:59]
  ds_read_b128 v[100:103], v19 offset:6144
  v_mfma_f32_16x16x32_bf16 a[60:63], v[116:119], v[52:55], a[60:63]
  buffer_load_dwordx4 v8, s[12:15], s40 offen offset:2048 lds
  v_mfma_f32_16x16x32_bf16 a[0:3], v[120:123], v[56:59], a[0:3]
  v_mfma_f32_16x16x32_bf16 a[4:7], v[120:123], v[60:63], a[4:7]
  buffer_load_dwordx4 v9, s[12:15], s40 offen offset:3072 lds
  v_mfma_f32_16x16x32_bf16 a[8:11], v[120:123], v[64:67], a[8:11]
  v_mfma_f32_16x16x32_bf16 a[12:15], v[120:123], v[68:71], a[12:15]
  v_mfma_f32_16x16x32_bf16 a[16:19], v[124:127], v[56:59], a[16:19]
  v_mfma_f32_16x16x32_bf16 a[20:23], v[124:127], v[60:63], a[20:23]
  v_mfma_f32_16x16x32_bf16 a[24:27], v[124:127], v[64:67], a[24:27]
  v_mfma_f32_16x16x32_bf16 a[28:31], v[124:127], v[68:71], a[28:31]
  v_mfma_f32_16x16x32_bf16 a[32:35], v[128:131], v[56:59], a[32:35]
  v_mfma_f32_16x16x32_bf16 a[36:39], v[128:131], v[60:63], a[36:39]
  v_mfma_f32_16x16x32_bf16 a[40:43], v[128:131], v[64:67], a[40:43]
  v_mfma_f32_16x16x32_bf16 a[44:47], v[128:131], v[68:71], a[44:47]
  v_mfma_f32_16x16x32_bf16 a[48:51], v[132:135], v[56:59], a[48:51]
  v_mfma_f32_16x16x32_bf16 a[52:55], v[132:135], v[60:63], a[52:55]
  v_mfma_f32_16x16x32_bf16 a[56:59], v[132:135], v[64:67], a[56:59]
  v_mfma_f32_16x16x32_bf16 a[60:63], v[132:135], v[68:71], a[60:63]
  s_add_u32 s38, s38, 1
  s_lshl_b32 s39, s38, 7
  s_and_b32 s40, s38, 15
  s_lshl_b32 s40, s40, 7
  s_cmp_lt_u32 s38, 16
  s_cselect_b32 s12, s74, s76
  s_cselect_b32 s13, s75, s77
  s_and_b32 s13, s13, 0xffff
  s_add_u32 s42, s42, 32768
  s_and_b32 s42, s42, 131071
  s_add_u32 s41, s41, 32768
  s_and_b32 s41, s41, 131071
  s_waitcnt vmcnt(16) lgkmcnt(0)
  s_barrier
  v_add_u32 v18, s41, v10
  v_add_u32 v19, s41, v11
  v_add_u32 v20, s41, v12
  v_add_u32 v21, s41, v13
  ds_read_b128 v[104:107], v20 offset:0
  v_mfma_f32_16x16x32_bf16 a[0:3], v[136:139], v[72:75], a[0:3]
  ds_read_b128 v[108:111], v20 offset:2048
  v_mfma_f32_16x16x32_bf16 a[4:7], v[136:139], v[76:79], a[4:7]
  ds_read_b128 v[112:115], v20 offset:4096
  v_mfma_f32_16x16x32_bf16 a[8:11], v[136:139], v[80:83], a[8:11]
  ds_read_b128 v[116:119], v20 offset:6144
  v_mfma_f32_16x16x32_bf16 a[12:15], v[136:139], v[84:87], a[12:15]
  ds_read_b128 v[40:43], v18 offset:0
  s_lshl_b32 s44, s32, 12
  s_add_u32 s44, s44, s42
  s_add_u32 m0, s44, 0
  s_nop 0
  buffer_load_dwordx4 v2, s[8:11], s39 offen offset:0 lds
  v_mfma_f32_16x16x32_bf16 a[16:19], v[140:143], v[72:75], a[16:19]
  ds_read_b128 v[44:47], v18 offset:2048
  v_mfma_f32_16x16x32_bf16 a[20:23], v[140:143], v[76:79], a[20:23]
  ds_read_b128 v[48:51], v18 offset:4096
  buffer_load_dwordx4 v3, s[8:11], s39 offen offset:1024 lds
  v_mfma_f32_16x16x32_bf16 a[24:27], v[140:143], v[80:83], a[24:27]
  ds_read_b128 v[52:55], v18 offset:6144
  v_mfma_f32_16x16x32_bf16 a[28:31], v[140:143], v[84:87], a[28:31]
  ds_read_b128 v[120:123], v21 offset:0
  buffer_load_dwordx4 v4, s[8:11], s39 offen offset:2048 lds
  v_mfma_f32_16x16x32_bf16 a[32:35], v[144:147], v[72:75], a[32:35]
  ds_read_b128 v[124:127], v21 offset:2048
  v_mfma_f32_16x16x32_bf16 a[36:39], v[144:147], v[76:79], a[36:39]
  ds_read_b128 v[128:131], v21 offset:4096
  buffer_load_dwordx4 v5, s[8:11], s39 offen offset:3072 lds
  v_mfma_f32_16x16x32_bf16 a[40:43], v[144:147], v[80:83], a[40:43]
  ds_read_b128 v[132:135], v21 offset:6144
  v_mfma_f32_16x16x32_bf16 a[44:47], v[144:147], v[84:87], a[44:47]
  ds_read_b128 v[56:59], v19 offset:0
  s_lshl_b32 s44, s32, 12
  s_add_u32 s44, s44, s42
  s_add_u32 m0, s44, 16384
  s_nop 0
  buffer_load_dwordx4 v6, s[12:15], s40 offen offset:0 lds
  v_mfma_f32_16x16x32_bf16 a[48:51], v[148:151], v[72:75], a[48:51]
  ds_read_b128 v[60:63], v19 offset:2048
  v_mfma_f32_16x16x32_bf16 a[52:55], v[148:151], v[76:79], a[52:55]
  ds_read_b128 v[64:67], v19 offset:4096
  buffer_load_dwordx4 v7, s[12:15], s40 offen offset:1024 lds
  v_mfma_f32_16x16x32_bf16 a[56:59], v[148:151], v[80:83], a[56:59]
  ds_read_b128 v[68:71], v19 offset:6144
  v_mfma_f32_16x16x32_bf16 a[60:63], v[148:151], v[84:87], a[60:63]
  buffer_load_dwordx4 v8, s[12:15], s40 offen offset:2048 lds
  v_mfma_f32_16x16x32_bf16 a[0:3], v[152:155], v[88:91], a[0:3]
  v_mfma_f32_16x16x32_bf16 a[4:7], v[152:155], v[92:95], a[4:7]
  buffer_load_dwordx4 v9, s[12:15], s40 offen offset:3072 lds
  v_mfma_f32_16x16x32_bf16 a[8:11], v[152:155], v[96:99], a[8:11]
  v_mfma_f32_16x16x32_bf16 a[12:15], v[152:155], v[100:103], a[12:15]
  v_mfma_f32_16x16x32_bf16 a[16:19], v[156:159], v[88:91], a[16:19]
  v_mfma_f32_16x16x32_bf16 a[20:23], v[156:159], v[92:95], a[20:23]
  v_mfma_f32_16x16x32_bf16 a[24:27], v[156:159], v[96:99], a[24:27]
  v_mfma_f32_16x16x32_bf16 a[28:31], v[156:159], v[100:103], a[28:31]
  v_mfma_f32_16x16x32_bf16 a[32:35], v[160:163], v[88:91], a[32:35]
  v_mfma_f32_16x16x32_bf16 a[36:39], v[160:163], v[92:95], a[36:39]
  v_mfma_f32_16x16x32_bf16 a[40:43], v[160:163], v[96:99], a[40:43]
  v_mfma_f32_16x16x32_bf16 a[44:47], v[160:163], v[100:103], a[44:47]
  v_mfma_f32_16x16x32_bf16 a[48:51], v[164:167], v[88:91], a[48:51]
  v_mfma_f32_16x16x32_bf16 a[52:55], v[164:167], v[92:95], a[52:55]
  v_mfma_f32_16x16x32_bf16 a[56:59], v[164:167], v[96:99], a[56:59]
  v_mfma_f32_16x16x32_bf16 a[60:63], v[164:167], v[100:103], a[60:63]
  s_add_u32 s38, s38, 1
  s_lshl_b32 s39, s38, 7
  s_and_b32 s40, s38, 15
  s_lshl_b32 s40, s40, 7
  s_cmp_lt_u32 s38, 16
  s_cselect_b32 s12, s74, s76
  s_cselect_b32 s13, s75, s77
  s_and_b32 s13, s13, 0xffff
  s_add_u32 s42, s42, 32768
  s_and_b32 s42, s42, 131071
  s_add_u32 s41, s41, 32768
  s_and_b32 s41, s41, 131071
  s_sub_u32 s37, s37, 2
  s_cmp_gt_u32 s37, 0
  s_cbranch_scc1 K3_seg0_2_loop
  s_waitcnt vmcnt(0)
  s_waitcnt lgkmcnt(0)
  s_barrier
  s_mov_b32 s37, 12
  s_mov_b32 s38, 0
  v_lshrrev_b32 v25, 3, v1
  v_and_b32 v24, 7, v1
  v_xor_b32 v24, v24, v25
  v_lshlrev_b32 v24, 4, v24
  s_mov_b32 s44, 7168
  v_mul_lo_u32 v25, s44, v25
  v_add_u32 v24, v24, v25
  s_lshl_b32 s3, s33, 2
  s_add_u32 s3, s3, s32
  s_mul_i32 s3, s3, 0x38000
  s_add_u32 s3, s3, 0x0
  s_add_u32 s4, s3, 0x0
  v_add_u32 v2, s4, v24
  s_add_u32 s4, s3, 0xdc00
  v_add_u32 v3, s4, v24
  s_add_u32 s4, s3, 0x1b800
  v_add_u32 v4, s4, v24
  s_add_u32 s4, s3, 0x29400
  v_add_u32 v5, s4, v24
  s_lshr_b32 s3, s32, 1
  s_lshl_b32 s3, s3, 5
  s_and_b32 s4, s32, 1
  s_lshl_b32 s4, s4, 2
  s_add_u32 s3, s3, s4
  s_lshl_b32 s3, s3, 11
  s_lshl_b32 s4, s34, 8
  s_add_u32 s3, s3, s4
  v_lshrrev_b32 v24, 4, v1
  v_add_u32 v25, 0, v24
  v_lshrrev_b32 v26, 1, v1
  v_and_b32 v26, 7, v26
  v_xor_b32 v25, v25, v26
  v_lshlrev_b32 v25, 5, v25
  v_and_b32 v26, 1, v1
  v_lshlrev_b32 v26, 4, v26
  v_lshlrev_b32 v24, 11, v24
  v_add3_u32 v24, v24, v25, v26
  s_add_u32 s4, s3, 0
  v_add_u32 v6, s4, v24
  v_lshrrev_b32 v24, 4, v1
  v_add_u32 v25, 4, v24
  v_lshrrev_b32 v26, 1, v1
  v_and_b32 v26, 7, v26
  v_xor_b32 v25, v25, v26
  v_lshlrev_b32 v25, 5, v25
  v_and_b32 v26, 1, v1
  v_lshlrev_b32 v26, 4, v26
  v_lshlrev_b32 v24, 11, v24
  v_add3_u32 v24, v24, v25, v26
  s_add_u32 s4, s3, 15360
  v_add_u32 v7, s4, v24
  v_lshrrev_b32 v24, 4, v1
  v_add_u32 v25, 0, v24
  v_lshrrev_b32 v26, 1, v1
  v_and_b32 v26, 7, v26
  v_xor_b32 v25, v25, v26
  v_lshlrev_b32 v25, 5, v25
  v_and_b32 v26, 1, v1
  v_lshlrev_b32 v26, 4, v26
  v_lshlrev_b32 v24, 11, v24
  v_add3_u32 v24, v24, v25, v26
  s_add_u32 s4, s3, 30720
  v_add_u32 v8, s4, v24
  v_lshrrev_b32 v24, 4, v1
  v_add_u32 v25, 4, v24
  v_lshrrev_b32 v26, 1, v1
  v_and_b32 v26, 7, v26
  v_xor_b32 v25, v25, v26
  v_lshlrev_b32 v25, 5, v25
  v_and_b32 v26, 1, v1
  v_lshlrev_b32 v26, 4, v26
  v_lshlrev_b32 v24, 11, v24
  v_add3_u32 v24, v24, v25, v26
  s_add_u32 s4, s3, 46080
  v_add_u32 v9, s4, v24
  s_sub_u32 s38, s38, 1
  s_mov_b32 s41, 0
  s_mov_b32 s42, 0
  s_add_u32 s38, s38, 1
  s_lshl_b32 s39, s38, 7
  s_lshl_b32 s40, s38, 17
  s_add_u32 s42, s42, 32768
  s_and_b32 s42, s42, 131071
  s_mov_b32 s42, 0
  s_lshl_b32 s44, s32, 12
  s_add_u32 s44, s44, s42
  s_add_u32 m0, s44, 0
  s_nop 0
  buffer_load_dwordx4 v2, s[8:11], s39 offen offset:0 lds
  buffer_load_dwordx4 v3, s[8:11], s39 offen offset:1024 lds
  buffer_load_dwordx4 v4, s[8:11], s39 offen offset:2048 lds
  buffer_load_dwordx4 v5, s[8:11], s39 offen offset:3072 lds
  s_lshl_b32 s44, s32, 12
  s_add_u32 s44, s44, s42
  s_add_u32 m0, s44, 16384
  s_nop 0
  buffer_load_dwordx4 v6, s[16:19], s40 offen offset:0 lds
  buffer_load_dwordx4 v7, s[16:19], s40 offen offset:1024 lds
  buffer_load_dwordx4 v8, s[16:19], s40 offen offset:2048 lds
  buffer_load_dwordx4 v9, s[16:19], s40 offen offset:3072 lds
  s_add_u32 s38, s38, 1
  s_lshl_b32 s39, s38, 7
  s_lshl_b32 s40, s38, 17
  s_add_u32 s42, s42, 32768
  s_and_b32 s42, s42, 131071
  s_lshl_b32 s44, s32, 12
  s_add_u32 s44, s44, s42
  s_add_u32 m0, s44, 0
  s_nop 0
  buffer_load_dwordx4 v2, s[8:11], s39 offen offset:0 lds
  buffer_load_dwordx4 v3, s[8:11], s39 offen offset:1024 lds
  buffer_load_dwordx4 v4, s[8:11], s39 offen offset:2048 lds
  buffer_load_dwordx4 v5, s[8:11], s39 offen offset:3072 lds
  s_lshl_b32 s44, s32, 12
  s_add_u32 s44, s44, s42
  s_add_u32 m0, s44, 16384
  s_nop 0
  buffer_load_dwordx4 v6, s[16:19], s40 offen offset:0 lds
  buffer_load_dwordx4 v7, s[16:19], s40 offen offset:1024 lds
  buffer_load_dwordx4 v8, s[16:19], s40 offen offset:2048 lds
  buffer_load_dwordx4 v9, s[16:19], s40 offen offset:3072 lds
  s_add_u32 s38, s38, 1
  s_lshl_b32 s39, s38, 7
  s_lshl_b32 s40, s38, 17
  s_add_u32 s42, s42, 32768
  s_and_b32 s42, s42, 131071
  s_lshl_b32 s44, s32, 12
  s_add_u32 s44, s44, s42
  s_add_u32 m0, s44, 0
  s_nop 0
  buffer_load_dwordx4 v2, s[8:11], s39 offen offset:0 lds
  buffer_load_dwordx4 v3, s[8:11], s39 offen offset:1024 lds
  buffer_load_dwordx4 v4, s[8:11], s39 offen offset:2048 lds
  buffer_load_dwordx4 v5, s[8:11], s39 offen offset:3072 lds
  s_lshl_b32 s44, s32, 12
  s_add_u32 s44, s44, s42
  s_add_u32 m0, s44, 16384
  s_nop 0
  buffer_load_dwordx4 v6, s[16:19], s40 offen offset:0 lds
  buffer_load_dwordx4 v7, s[16:19], s40 offen offset:1024 lds
  buffer_load_dwordx4 v8, s[16:19], s40 offen offset:2048 lds
  buffer_load_dwordx4 v9, s[16:19], s40 offen offset:3072 lds
  s_add_u32 s38, s38, 1
  s_lshl_b32 s39, s38, 7
  s_lshl_b32 s40, s38, 17
  s_add_u32 s42, s42, 32768
  s_and_b32 s42, s42, 131071
  s_lshl_b32 s44, s32, 12
  s_add_u32 s44, s44, s42
  s_add_u32 m0, s44, 0
  s_nop 0
  buffer_load_dwordx4 v2, s[8:11], s39 offen offset:0 lds
  buffer_load_dwordx4 v3, s[8:11], s39 offen offset:1024 lds
  buffer_load_dwordx4 v4, s[8:11], s39 offen offset:2048 lds
  buffer_load_dwordx4 v5, s[8:11], s39 offen offset:3072 lds
  s_lshl_b32 s44, s32, 12
  s_add_u32 s44, s44, s42
  s_add_u32 m0, s44, 16384
  s_nop 0
  buffer_load_dwordx4 v6, s[16:19], s40 offen offset:0 lds
  buffer_load_dwordx4 v7, s[16:19], s40 offen offset:1024 lds
  buffer_load_dwordx4 v8, s[16:19], s40 offen offset:2048 lds
  buffer_load_dwordx4 v9, s[16:19], s40 offen offset:3072 lds
  s_add_u32 s38, s38, 1
  s_lshl_b32 s39, s38, 7
  s_lshl_b32 s40, s38, 17
  s_add_u32 s42, s42, 32768
  s_and_b32 s42, s42, 131071
  s_waitcnt vmcnt(24)
  s_barrier
  v_add_u32 v18, s41, v10
  v_add_u32 v19, s41, v11
  v_add_u32 v20, s41, v14
  v_add_u32 v21, s41, v15
  v_add_u32 v22, s41, v16
  v_add_u32 v23, s41, v17
  ds_read_b64_tr_b16 v[104:105], v20 offset:0
  ds_read_b64_tr_b16 v[106:107], v20 offset:4096
  ds_read_b64_tr_b16 v[108:109], v21 offset:0
  ds_read_b64_tr_b16 v[110:111], v21 offset:4096
  ds_read_b64_tr_b16 v[112:113], v22 offset:0
  ds_read_b64_tr_b16 v[114:115], v22 offset:4096
  ds_read_b64_tr_b16 v[116:117], v23 offset:0
  ds_read_b64_tr_b16 v[118:119], v23 offset:4096
  ds_read_b128 v[40:43], v18 offset:0
  ds_read_b128 v[44:47], v18 offset:2048
  ds_read_b128 v[48:51], v18 offset:4096
  ds_read_b128 v[52:55], v18 offset:6144
  ds_read_b64_tr_b16 v[120:121], v20 offset:8192
  ds_read_b64_tr_b16 v[122:123], v20 offset:12288
  ds_read_b64_tr_b16 v[124:125], v21 offset:8192
  ds_read_b64_tr_b16 v[126:127], v21 offset:12288
  ds_read_b64_tr_b16 v[128:129], v22 offset:8192
  ds_read_b64_tr_b16 v[130:131], v22 offset:12288
  ds_read_b64_tr_b16 v[132:133], v23 offset:8192
  ds_read_b64_tr_b16 v[134:135], v23 offset:12288
  ds_read_b128 v[56:59], v19 offset:0
  ds_read_b128 v[60:63], v19 offset:2048
  ds_read_b128 v[64:67], v19 offset:4096
  ds_read_b128 v[68:71], v19 offset:6144
  s_add_u32 s41, s41, 32768
  s_and_b32 s41, s41, 131071
K3_seg1_3_loop:
  s_waitcnt vmcnt(16) lgkmcnt(0)
  s_barrier
  v_add_u32 v18, s41, v10
  v_add_u32 v19, s41, v11
  v_add_u32 v20, s41, v14
  v_add_u32 v21, s41, v15
  v_add_u32 v22, s41, v16
  v_add_u32 v23, s41, v17
  ds_read_b64_tr_b16 v[136:137], v20 offset:0
  v_mfma_f32_16x16x32_bf16 a[64:67], v[104:107], v[40:43], a[64:67]
  ds_read_b64_tr_b16 v[138:139], v20 offset:4096
  v_mfma_f32_16x16x32_bf16 a[68:71], v[104:107], v[44:47], a[68:71]
  ds_read_b64_tr_b16 v[140:141], v21 offset:0
  v_mfma_f32_16x16x32_bf16 a[72:75], v[104:107], v[48:51], a[72:75]
  ds_read_b64_tr_b16 v[142:143], v21 offset:4096
  v_mfma_f32_16x16x32_bf16 a[76:79], v[104:107], v[52:55], a[76:79]
  ds_read_b64_tr_b16 v[144:145], v22 offset:0
  s_lshl_b32 s44, s32, 12
  s_add_u32 s44, s44, s42
  s_add_u32 m0, s44, 0
  s_nop 0
  buffer_load_dwordx4 v2, s[8:11], s39 offen offset:0 lds
  v_mfma_f32_16x16x32_bf16 a[80:83], v[108:111], v[40:43], a[80:83]
  ds_read_b64_tr_b16 v[146:147], v22 offset:4096
  v_mfma_f32_16x16x32_bf16 a[84:87], v[108:111], v[44:47], a[84:87]
  ds_read_b64_tr_b16 v[148:149], v23 offset:0
  buffer_load_dwordx4 v3, s[8:11], s39 offen offset:1024 lds
  v_mfma_f32_16x16x32_bf16 a[88:91], v[108:111], v[48:51], a[88:91]
  ds_read_b64_tr_b16 v[150:151], v23 offset:4096
  v_mfma_f32_16x16x32_bf16 a[92:95], v[108:111], v[52:55], a[92:95]
  ds_read_b128 v[72:75], v18 offset:0
  buffer_load_dwordx4 v4, s[8:11], s39 offen offset:2048 lds
  v_mfma_f32_16x16x32_bf16 a[96:99], v[112:115], v[40:43], a[96:99]
  ds_read_b128 v[76:79], v18 offset:2048
  v_mfma_f32_16x16x32_bf16 a[100:103], v[112:115], v[44:47], a[100:103]
  ds_read_b128 v[80:83], v18 offset:4096
  buffer_load_dwordx4 v5, s[8:11], s39 offen offset:3072 lds
  v_mfma_f32_16x16x32_bf16 a[104:107], v[112:115], v[48:51], a[104:107]
  ds_read_b128 v[84:87], v18 offset:6144
  v_mfma_f32_16x16x32_bf16 a[108:111], v[112:115], v[52:55], a[108:111]
  ds_read_b64_tr_b16 v[152:153], v20 offset:8192
  s_lshl_b32 s44, s32, 12
  s_add_u32 s44, s44, s42
  s_add_u32 m0, s44, 16384
  s_nop 0
  buffer_load_dwordx4 v6, s[16:19], s40 offen offset:0 lds
  v_mfma_f32_16x16x32_bf16 a[112:115], v[116:119], v[40:43], a[112:115]
  ds_read_b64_tr_b16 v[154:155], v20 offset:12288
  v_mfma_f32_16x16x32_bf16 a[116:119], v[116:119], v[44:47], a[116:119]
  ds_read_b64_tr_b16 v[156:157], v21 offset:8192
  buffer_load_dwordx4 v7, s[16:19], s40 offen offset:1024 lds
  v_mfma_f32_16x16x32_bf16 a[120:123], v[116:119], v[48:51], a[120:123]
  ds_read_b64_tr_b16 v[158:159], v21 offset:12288
  v_mfma_f32_16x16x32_bf16 a[124:127], v[116:119], v[52:55], a[124:127]
  ds_read_b64_tr_b16 v[160:161], v22 offset:8192
  buffer_load_dwordx4 v8, s[16:19], s40 offen offset:2048 lds
  v_mfma_f32_16x16x32_bf16 a[64:67], v[120:123], v[56:59], a[64:67]
  ds_read_b64_tr_b16 v[162:163], v22 offset:12288
  v_mfma_f32_16x16x32_bf16 a[68:71], v[120:123], v[60:63], a[68:71]
  ds_read_b64_tr_b16 v[164:165], v23 offset:8192
  buffer_load_dwordx4 v9, s[16:19], s40 offen offset:3072 lds
  v_mfma_f32_16x16x32_bf16 a[72:75], v[120:123], v[64:67], a[72:75]
  ds_read_b64_tr_b16 v[166:167], v23 offset:12288
  v_mfma_f32_16x16x32_bf16 a[76:79], v[120:123], v[68:71], a[76:79]
  ds_read_b128 v[88:91], v19 offset:0
  v_mfma_f32_16x16x32_bf16 a[80:83], v[124:127], v[56:59], a[80:83]
  ds_read_b128 v[92:95], v19 offset:2048
  v_mfma_f32_16x16x32_bf16 a[84:87], v[124:127], v[60:63], a[84:87]
  ds_read_b128 v[96:99], v19 offset:4096
  v_mfma_f32_16x16x32_bf16 a[88:91], v[124:127], v[64:67], a[88:91]
  ds_read_b128 v[100:103], v19 offset:6144
  v_mfma_f32_16x16x32_bf16 a[92:95], v[124:127], v[68:71], a[92:95]
  v_mfma_f32_16x16x32_bf16 a[96:99], v[128:131], v[56:59], a[96:99]
  v_mfma_f32_16x16x32_bf16 a[100:103], v[128:131], v[60:63], a[100:103]
  v_mfma_f32_16x16x32_bf16 a[104:107], v[128:131], v[64:67], a[104:107]
  v_mfma_f32_16x16x32_bf16 a[108:111], v[128:131], v[68:71], a[108:111]
  v_mfma_f32_16x16x32_bf16 a[112:115], v[132:135], v[56:59], a[112:115]
  v_mfma_f32_16x16x32_bf16 a[116:119], v[132:135], v[60:63], a[116:119]
  v_mfma_f32_16x16x32_bf16 a[120:123], v[132:135], v[64:67], a[120:123]
  v_mfma_f32_16x16x32_bf16 a[124:127], v[132:135], v[68:71], a[124:127]
  s_add_u32 s38, s38, 1
  s_lshl_b32 s39, s38, 7
  s_lshl_b32 s40, s38, 17
  s_add_u32 s42, s42, 32768
  s_and_b32 s42, s42, 131071
  s_add_u32 s41, s41, 32768
  s_and_b32 s41, s41, 131071
  s_waitcnt vmcnt(16) lgkmcnt(0)
  s_barrier
  v_add_u32 v18, s41, v10
  v_add_u32 v19, s41, v11
  v_add_u32 v20, s41, v14
  v_add_u32 v21, s41, v15
  v_add_u32 v22, s41, v16
  v_add_u32 v23, s41, v17
  ds_read_b64_tr_b16 v[104:105], v20 offset:0
  v_mfma_f32_16x16x32_bf16 a[64:67], v[136:139], v[72:75], a[64:67]
  ds_read_b64_tr_b16 v[106:107], v20 offset:4096
  v_mfma_f32_16x16x32_bf16 a[68:71], v[136:139], v[76:79], a[68:71]
  ds_read_b64_tr_b16 v[108:109], v21 offset:0
  v_mfma_f32_16x16x32_bf16 a[72:75], v[136:139], v[80:83], a[72:75]
  ds_read_b64_tr_b16 v[110:111], v21 offset:4096
  v_mfma_f32_16x16x32_bf16 a[76:79], v[136:139], v[84:87], a[76:79]
  ds_read_b64_tr_b16 v[112:113], v22 offset:0
  s_lshl_b32 s44, s32, 12
  s_add_u32 s44, s44, s42
  s_add_u32 m0, s44, 0
  s_nop 0
  buffer_load_dwordx4 v2, s[8:11], s39 offen offset:0 lds
  v_mfma_f32_16x16x32_bf16 a[80:83], v[140:143], v[72:75], a[80:83]
  ds_read_b64_tr_b16 v[114:115], v22 offset:4096
  v_mfma_f32_16x16x32_bf16 a[84:87], v[140:143], v[76:79], a[84:87]
  ds_read_b64_tr_b16 v[116:117], v23 offset:0
  buffer_load_dwordx4 v3, s[8:11], s39 offen offset:1024 lds
  v_mfma_f32_16x16x32_bf16 a[88:91], v[140:143], v[80:83], a[88:91]
  ds_read_b64_tr_b16 v[118:119], v23 offset:4096
  v_mfma_f32_16x16x32_bf16 a[92:95], v[140:143], v[84:87], a[92:95]
  ds_read_b128 v[40:43], v18 offset:0
  buffer_load_dwordx4 v4, s[8:11], s39 offen offset:2048 lds
  v_mfma_f32_16x16x32_bf16 a[96:99], v[144:147], v[72:75], a[96:99]
  ds_read_b128 v[44:47], v18 offset:2048
  v_mfma_f32_16x16x32_bf16 a[100:103], v[144:147], v[76:79], a[100:103]
  ds_read_b128 v[48:51], v18 offset:4096
  buffer_load_dwordx4 v5, s[8:11], s39 offen offset:3072 lds
  v_mfma_f32_16x16x32_bf16 a[104:107], v[144:147], v[80:83], a[104:107]
  ds_read_b128 v[52:55], v18 offset:6144
  v_mfma_f32_16x16x32_bf16 a[108:111], v[144:147], v[84:87], a[108:111]
  ds_read_b64_tr_b16 v[120:121], v20 offset:8192
  s_lshl_b32 s44, s32, 12
  s_add_u32 s44, s44, s42
  s_add_u32 m0, s44, 16384
  s_nop 0
  buffer_load_dwordx4 v6, s[16:19], s40 offen offset:0 lds
  v_mfma_f32_16x16x32_bf16 a[112:115], v[148:151], v[72:75], a[112:115]
  ds_read_b64_tr_b16 v[122:123], v20 offset:12288
  v_mfma_f32_16x16x32_bf16 a[116:119], v[148:151], v[76:79], a[116:119]
  ds_read_b64_tr_b16 v[124:125], v21 offset:8192
  buffer_load_dwordx4 v7, s[16:19], s40 offen offset:1024 lds
  v_mfma_f32_16x16x32_bf16 a[120:123], v[148:151], v[80:83], a[120:123]
  ds_read_b64_tr_b16 v[126:127], v21 offset:12288
  v_mfma_f32_16x16x32_bf16 a[124:127], v[148:151], v[84:87], a[124:127]
  ds_read_b64_tr_b16 v[128:129], v22 offset:8192
  buffer_load_dwordx4 v8, s[16:19], s40 offen offset:2048 lds
  v_mfma_f32_16x16x32_bf16 a[64:67], v[152:155], v[88:91], a[64:67]
  ds_read_b64_tr_b16 v[130:131], v22 offset:12288
  v_mfma_f32_16x16x32_bf16 a[68:71], v[152:155], v[92:95], a[68:71]
  ds_read_b64_tr_b16 v[132:133], v23 offset:8192
  buffer_load_dwordx4 v9, s[16:19], s40 offen offset:3072 lds
  v_mfma_f32_16x16x32_bf16 a[72:75], v[152:155], v[96:99], a[72:75]
  ds_read_b64_tr_b16 v[134:135], v23 offset:12288
  v_mfma_f32_16x16x32_bf16 a[76:79], v[152:155], v[100:103], a[76:79]
  ds_read_b128 v[56:59], v19 offset:0
  v_mfma_f32_16x16x32_bf16 a[80:83], v[156:159], v[88:91], a[80:83]
  ds_read_b128 v[60:63], v19 offset:2048
  v_mfma_f32_16x16x32_bf16 a[84:87], v[156:159], v[92:95], a[84:87]
  ds_read_b128 v[64:67], v19 offset:4096
  v_mfma_f32_16x16x32_bf16 a[88:91], v[156:159], v[96:99], a[88:91]
  ds_read_b128 v[68:71], v19 offset:6144
  v_mfma_f32_16x16x32_bf16 a[92:95], v[156:159], v[100:103], a[92:95]
  v_mfma_f32_16x16x32_bf16 a[96:99], v[160:163], v[88:91], a[96:99]
  v_mfma_f32_16x16x32_bf16 a[100:103], v[160:163], v[92:95], a[100:103]
  v_mfma_f32_16x16x32_bf16 a[104:107], v[160:163], v[96:99], a[104:107]
  v_mfma_f32_16x16x32_bf16 a[108:111], v[160:163], v[100:103], a[108:111]
  v_mfma_f32_16x16x32_bf16 a[112:115], v[164:167], v[88:91], a[112:115]
  v_mfma_f32_16x16x32_bf16 a[116:119], v[164:167], v[92:95], a[116:119]
  v_mfma_f32_16x16x32_bf16 a[120:123], v[164:167], v[96:99], a[120:123]
  v_mfma_f32_16x16x32_bf16 a[124:127], v[164:167], v[100:103], a[124:127]
  s_add_u32 s38, s38, 1
  s_lshl_b32 s39, s38, 7
  s_lshl_b32 s40, s38, 17
  s_add_u32 s42, s42, 32768
  s_and_b32 s42, s42, 131071
  s_add_u32 s41, s41, 32768
  s_and_b32 s41, s41, 131071
  s_sub_u32 s37, s37, 2
  s_cmp_gt_u32 s37, 0
  s_cbranch_scc1 K3_seg1_3_loop
  s_waitcnt vmcnt(0)
  s_waitcnt lgkmcnt(0)
  s_barrier
  s_lshl_b32 s3, s33, 7
  s_lshl_b32 s4, s36, 6
  s_add_u32 s3, s3, s4
  v_and_b32 v26, 15, v1
  v_add_u32 v26, s3, v26
  s_lshl_b32 s3, s34, 7
  s_lshl_b32 s4, s52, 6
  s_add_u32 s3, s3, s4
  v_lshrrev_b32 v27, 4, v1
  v_lshlrev_b32 v27, 2, v27
  v_add_u32 v27, s3, v27
  v_lshlrev_b32 v28, 2, v26
  v_add_u32 v28, 0x2900000, v28
  buffer_load_dword v40, v28, s[8:11], 0 offen offset:0
  buffer_load_dword v41, v28, s[8:11], 0 offen offset:64
  buffer_load_dword v42, v28, s[8:11], 0 offen offset:128
  buffer_load_dword v43, v28, s[8:11], 0 offen offset:192
  v_lshlrev_b32 v28, 1, v27
  buffer_load_dwordx2 v[44:45], v28, s[28:31], 0 offen offset:0
  buffer_load_dwordx2 v[46:47], v28, s[28:31], 0 offen offset:32
  buffer_load_dwordx2 v[48:49], v28, s[28:31], 0 offen offset:64
  buffer_load_dwordx2 v[50:51], v28, s[28:31], 0 offen offset:96
  v_lshlrev_b32 v29, 11, v26
  v_add_u32 v28, v28, v29
  buffer_load_dwordx2 v[52:53], v28, s[20:23], 0 offen offset:0
  buffer_load_dwordx2 v[54:55], v28, s[20:23], 0 offen offset:32
  buffer_load_dwordx2 v[56:57], v28, s[20:23], 0 offen offset:64
  buffer_load_dwordx2 v[58:59], v28, s[20:23], 0 offen offset:96
  v_add_u32 v28, 0x8000, v28
  buffer_load_dwordx2 v[60:61], v28, s[20:23], 0 offen offset:0
  buffer_load_dwordx2 v[62:63], v28, s[20:23], 0 offen offset:32
  buffer_load_dwordx2 v[64:65], v28, s[20:23], 0 offen offset:64
  buffer_load_dwordx2 v[66:67], v28, s[20:23], 0 offen offset:96
  v_add_u32 v28, 0x8000, v28
  buffer_load_dwordx2 v[68:69], v28, s[20:23], 0 offen offset:0
  buffer_load_dwordx2 v[70:71], v28, s[20:23], 0 offen offset:32
  buffer_load_dwordx2 v[72:73], v28, s[20:23], 0 offen offset:64
  buffer_load_dwordx2 v[74:75], v28, s[20:23], 0 offen offset:96
  v_add_u32 v28, 0x8000, v28
  buffer_load_dwordx2 v[76:77], v28, s[20:23], 0 offen offset:0
  buffer_load_dwordx2 v[78:79], v28, s[20:23], 0 offen offset:32
  buffer_load_dwordx2 v[80:81], v28, s[20:23], 0 offen offset:64
  buffer_load_dwordx2 v[82:83], v28, s[20:23], 0 offen offset:96
  v_add_u32 v28, 0x8000, v28
  v_lshlrev_b32 v30, 12, v26
  v_lshlrev_b32 v31, 2, v27
  v_add_u32 v30, v30, v31
  s_waitcnt vmcnt(0)
  v_sub_f32 v220, 1.0, v40
  v_cvt_pk_bf16_f32 v220, v220, v220
  v_lshlrev_b32 v220, 16, v220
  v_accvgpr_read_b32 v156, a0
  v_accvgpr_read_b32 v157, a1
  v_accvgpr_read_b32 v158, a2
  v_accvgpr_read_b32 v159, a3
  v_lshlrev_b32 v236, 16, v52
  v_and_b32 v237, 0xffff0000, v52
  v_lshlrev_b32 v238, 16, v44
  v_and_b32 v239, 0xffff0000, v44
  v_mul_f32 v236, v236, v238
  v_mul_f32 v237, v237, v239
  v_cvt_pk_bf16_f32 v238, v236, v237
  v_lshlrev_b32 v236, 16, v238
  v_and_b32 v237, 0xffff0000, v238
  v_fma_f32 v156, 2.0, v156, v236
  v_fma_f32 v157, 2.0, v157, v237
  v_mul_f32 v156, v40, v156
  v_mul_f32 v157, v40, v157
  v_lshlrev_b32 v240, 16, v53
  v_and_b32 v241, 0xffff0000, v53
  v_lshlrev_b32 v242, 16, v45
  v_and_b32 v243, 0xffff0000, v45
  v_mul_f32 v240, v240, v242
  v_mul_f32 v241, v241, v243
  v_cvt_pk_bf16_f32 v242, v240, v241
  v_lshlrev_b32 v240, 16, v242
  v_and_b32 v241, 0xffff0000, v242
  v_fma_f32 v158, 2.0, v158, v240
  v_fma_f32 v159, 2.0, v159, v241
  v_mul_f32 v158, v40, v158
  v_mul_f32 v159, v40, v159
  v_accvgpr_read_b32 v172, a16
  v_accvgpr_read_b32 v173, a17
  v_accvgpr_read_b32 v174, a18
  v_accvgpr_read_b32 v175, a19
  v_lshlrev_b32 v236, 16, v54
  v_and_b32 v237, 0xffff0000, v54
  v_lshlrev_b32 v238, 16, v46
  v_and_b32 v239, 0xffff0000, v46
  v_mul_f32 v236, v236, v238
  v_mul_f32 v237, v237, v239
  v_cvt_pk_bf16_f32 v238, v236, v237
  v_lshlrev_b32 v236, 16, v238
  v_and_b32 v237, 0xffff0000, v238
  v_fma_f32 v172, 2.0, v172, v236
  v_fma_f32 v173, 2.0, v173, v237
  v_mul_f32 v172, v40, v172
  v_mul_f32 v173, v40, v173
  v_lshlrev_b32 v240, 16, v55
  v_and_b32 v241, 0xffff0000, v55
  v_lshlrev_b32 v242, 16, v47
  v_and_b32 v243, 0xffff0000, v47
  v_mul_f32 v240, v240, v242
  v_mul_f32 v241, v241, v243
  v_cvt_pk_bf16_f32 v242, v240, v241
  v_lshlrev_b32 v240, 16, v242
  v_and_b32 v241, 0xffff0000, v242
  v_fma_f32 v174, 2.0, v174, v240
  v_fma_f32 v175, 2.0, v175, v241
  v_mul_f32 v174, v40, v174
  v_mul_f32 v175, v40, v175
  v_accvgpr_read_b32 v188, a32
  v_accvgpr_read_b32 v189, a33
  v_accvgpr_read_b32 v190, a34
  v_accvgpr_read_b32 v191, a35
  v_lshlrev_b32 v236, 16, v56
  v_and_b32 v237, 0xffff0000, v56
  v_lshlrev_b32 v238, 16, v48
  v_and_b32 v239, 0xffff0000, v48
  v_mul_f32 v236, v236, v238
  v_mul_f32 v237, v237, v239
  v_cvt_pk_bf16_f32 v238, v236, v237
  v_lshlrev_b32 v236, 16, v238
  v_and_b32 v237, 0xffff0000, v238
  v_fma_f32 v188, 2.0, v188, v236
  v_fma_f32 v189, 2.0, v189, v237
  v_mul_f32 v188, v40, v188
  v_mul_f32 v189, v40, v189
  v_lshlrev_b32 v240, 16, v57
  v_and_b32 v241, 0xffff0000, v57
  v_lshlrev_b32 v242, 16, v49
  v_and_b32 v243, 0xffff0000, v49
  v_mul_f32 v240, v240, v242
  v_mul_f32 v241, v241, v243
  v_cvt_pk_bf16_f32 v242, v240, v241
  v_lshlrev_b32 v240, 16, v242
  v_and_b32 v241, 0xffff0000, v242
  v_fma_f32 v190, 2.0, v190, v240
  v_fma_f32 v191, 2.0, v191, v241
  v_mul_f32 v190, v40, v190
  v_mul_f32 v191, v40, v191
  v_accvgpr_read_b32 v204, a48
  v_accvgpr_read_b32 v205, a49
  v_accvgpr_read_b32 v206, a50
  v_accvgpr_read_b32 v207, a51
  v_lshlrev_b32 v236, 16, v58
  v_and_b32 v237, 0xffff0000, v58
  v_lshlrev_b32 v238, 16, v50
  v_and_b32 v239, 0xffff0000, v50
  v_mul_f32 v236, v236, v238
  v_mul_f32 v237, v237, v239
  v_cvt_pk_bf16_f32 v238, v236, v237
  v_lshlrev_b32 v236, 16, v238
  v_and_b32 v237, 0xffff0000, v238
  v_fma_f32 v204, 2.0, v204, v236
  v_fma_f32 v205, 2.0, v205, v237
  v_mul_f32 v204, v40, v204
  v_mul_f32 v205, v40, v205
  v_lshlrev_b32 v240, 16, v59
  v_and_b32 v241, 0xffff0000, v59
  v_lshlrev_b32 v242, 16, v51
  v_and_b32 v243, 0xffff0000, v51
  v_mul_f32 v240, v240, v242
  v_mul_f32 v241, v241, v243
  v_cvt_pk_bf16_f32 v242, v240, v241
  v_lshlrev_b32 v240, 16, v242
  v_and_b32 v241, 0xffff0000, v242
  v_fma_f32 v206, 2.0, v206, v240
  v_fma_f32 v207, 2.0, v207, v241
  v_mul_f32 v206, v40, v206
  v_mul_f32 v207, v40, v207
  v_sub_f32 v221, 1.0, v41
  v_cvt_pk_bf16_f32 v221, v221, v221
  v_lshlrev_b32 v221, 16, v221
  v_accvgpr_read_b32 v160, a4
  v_accvgpr_read_b32 v161, a5
  v_accvgpr_read_b32 v162, a6
  v_accvgpr_read_b32 v163, a7
  v_lshlrev_b32 v236, 16, v60
  v_and_b32 v237, 0xffff0000, v60
  v_lshlrev_b32 v238, 16, v44
  v_and_b32 v239, 0xffff0000, v44
  v_mul_f32 v236, v236, v238
  v_mul_f32 v237, v237, v239
  v_cvt_pk_bf16_f32 v238, v236, v237
  v_lshlrev_b32 v236, 16, v238
  v_and_b32 v237, 0xffff0000, v238
  v_fma_f32 v160, 2.0, v160, v236
  v_fma_f32 v161, 2.0, v161, v237
  v_mul_f32 v160, v41, v160
  v_mul_f32 v161, v41, v161
  v_lshlrev_b32 v240, 16, v61
  v_and_b32 v241, 0xffff0000, v61
  v_lshlrev_b32 v242, 16, v45
  v_and_b32 v243, 0xffff0000, v45
  v_mul_f32 v240, v240, v242
  v_mul_f32 v241, v241, v243
  v_cvt_pk_bf16_f32 v242, v240, v241
  v_lshlrev_b32 v240, 16, v242
  v_and_b32 v241, 0xffff0000, v242
  v_fma_f32 v162, 2.0, v162, v240
  v_fma_f32 v163, 2.0, v163, v241
  v_mul_f32 v162, v41, v162
  v_mul_f32 v163, v41, v163
  v_accvgpr_read_b32 v176, a20
  v_accvgpr_read_b32 v177, a21
  v_accvgpr_read_b32 v178, a22
  v_accvgpr_read_b32 v179, a23
  v_lshlrev_b32 v236, 16, v62
  v_and_b32 v237, 0xffff0000, v62
  v_lshlrev_b32 v238, 16, v46
  v_and_b32 v239, 0xffff0000, v46
  v_mul_f32 v236, v236, v238
  v_mul_f32 v237, v237, v239
  v_cvt_pk_bf16_f32 v238, v236, v237
  v_lshlrev_b32 v236, 16, v238
  v_and_b32 v237, 0xffff0000, v238
  v_fma_f32 v176, 2.0, v176, v236
  v_fma_f32 v177, 2.0, v177, v237
  v_mul_f32 v176, v41, v176
  v_mul_f32 v177, v41, v177
  v_lshlrev_b32 v240, 16, v63
  v_and_b32 v241, 0xffff0000, v63
  v_lshlrev_b32 v242, 16, v47
  v_and_b32 v243, 0xffff0000, v47
  v_mul_f32 v240, v240, v242
  v_mul_f32 v241, v241, v243
  v_cvt_pk_bf16_f32 v242, v240, v241
  v_lshlrev_b32 v240, 16, v242
  v_and_b32 v241, 0xffff0000, v242
  v_fma_f32 v178, 2.0, v178, v240
  v_fma_f32 v179, 2.0, v179, v241
  v_mul_f32 v178, v41, v178
  v_mul_f32 v179, v41, v179
  v_accvgpr_read_b32 v192, a36
  v_accvgpr_read_b32 v193, a37
  v_accvgpr_read_b32 v194, a38
  v_accvgpr_read_b32 v195, a39
  v_lshlrev_b32 v236, 16, v64
  v_and_b32 v237, 0xffff0000, v64
  v_lshlrev_b32 v238, 16, v48
  v_and_b32 v239, 0xffff0000, v48
  v_mul_f32 v236, v236, v238
  v_mul_f32 v237, v237, v239
  v_cvt_pk_bf16_f32 v238, v236, v237
  v_lshlrev_b32 v236, 16, v238
  v_and_b32 v237, 0xffff0000, v238
  v_fma_f32 v192, 2.0, v192, v236
  v_fma_f32 v193, 2.0, v193, v237
  v_mul_f32 v192, v41, v192
  v_mul_f32 v193, v41, v193
  v_lshlrev_b32 v240, 16, v65
  v_and_b32 v241, 0xffff0000, v65
  v_lshlrev_b32 v242, 16, v49
  v_and_b32 v243, 0xffff0000, v49
  v_mul_f32 v240, v240, v242
  v_mul_f32 v241, v241, v243
  v_cvt_pk_bf16_f32 v242, v240, v241
  v_lshlrev_b32 v240, 16, v242
  v_and_b32 v241, 0xffff0000, v242
  v_fma_f32 v194, 2.0, v194, v240
  v_fma_f32 v195, 2.0, v195, v241
  v_mul_f32 v194, v41, v194
  v_mul_f32 v195, v41, v195
  v_accvgpr_read_b32 v208, a52
  v_accvgpr_read_b32 v209, a53
  v_accvgpr_read_b32 v210, a54
  v_accvgpr_read_b32 v211, a55
  v_lshlrev_b32 v236, 16, v66
  v_and_b32 v237, 0xffff0000, v66
  v_lshlrev_b32 v238, 16, v50
  v_and_b32 v239, 0xffff0000, v50
  v_mul_f32 v236, v236, v238
  v_mul_f32 v237, v237, v239
  v_cvt_pk_bf16_f32 v238, v236, v237
  v_lshlrev_b32 v236, 16, v238
  v_and_b32 v237, 0xffff0000, v238
  v_fma_f32 v208, 2.0, v208, v236
  v_fma_f32 v209, 2.0, v209, v237
  v_mul_f32 v208, v41, v208
  v_mul_f32 v209, v41, v209
  v_lshlrev_b32 v240, 16, v67
  v_and_b32 v241, 0xffff0000, v67
  v_lshlrev_b32 v242, 16, v51
  v_and_b32 v243, 0xffff0000, v51
  v_mul_f32 v240, v240, v242
  v_mul_f32 v241, v241, v243
  v_cvt_pk_bf16_f32 v242, v240, v241
  v_lshlrev_b32 v240, 16, v242
  v_and_b32 v241, 0xffff0000, v242
  v_fma_f32 v210, 2.0, v210, v240
  v_fma_f32 v211, 2.0, v211, v241
  v_mul_f32 v210, v41, v210
  v_mul_f32 v211, v41, v211
  v_sub_f32 v222, 1.0, v42
  v_cvt_pk_bf16_f32 v222, v222, v222
  v_lshlrev_b32 v222, 16, v222
  v_accvgpr_read_b32 v164, a8
  v_accvgpr_read_b32 v165, a9
  v_accvgpr_read_b32 v166, a10
  v_accvgpr_read_b32 v167, a11
  v_lshlrev_b32 v236, 16, v68
  v_and_b32 v237, 0xffff0000, v68
  v_lshlrev_b32 v238, 16, v44
  v_and_b32 v239, 0xffff0000, v44
  v_mul_f32 v236, v236, v238
  v_mul_f32 v237, v237, v239
  v_cvt_pk_bf16_f32 v238, v236, v237
  v_lshlrev_b32 v236, 16, v238
  v_and_b32 v237, 0xffff0000, v238
  v_fma_f32 v164, 2.0, v164, v236
  v_fma_f32 v165, 2.0, v165, v237
  v_mul_f32 v164, v42, v164
  v_mul_f32 v165, v42, v165
  v_lshlrev_b32 v240, 16, v69
  v_and_b32 v241, 0xffff0000, v69
  v_lshlrev_b32 v242, 16, v45
  v_and_b32 v243, 0xffff0000, v45
  v_mul_f32 v240, v240, v242
  v_mul_f32 v241, v241, v243
  v_cvt_pk_bf16_f32 v242, v240, v241
  v_lshlrev_b32 v240, 16, v242
  v_and_b32 v241, 0xffff0000, v242
  v_fma_f32 v166, 2.0, v166, v240
  v_fma_f32 v167, 2.0, v167, v241
  v_mul_f32 v166, v42, v166
  v_mul_f32 v167, v42, v167
  v_accvgpr_read_b32 v180, a24
  v_accvgpr_read_b32 v181, a25
  v_accvgpr_read_b32 v182, a26
  v_accvgpr_read_b32 v183, a27
  v_lshlrev_b32 v236, 16, v70
  v_and_b32 v237, 0xffff0000, v70
  v_lshlrev_b32 v238, 16, v46
  v_and_b32 v239, 0xffff0000, v46
  v_mul_f32 v236, v236, v238
  v_mul_f32 v237, v237, v239
  v_cvt_pk_bf16_f32 v238, v236, v237
  v_lshlrev_b32 v236, 16, v238
  v_and_b32 v237, 0xffff0000, v238
  v_fma_f32 v180, 2.0, v180, v236
  v_fma_f32 v181, 2.0, v181, v237
  v_mul_f32 v180, v42, v180
  v_mul_f32 v181, v42, v181
  v_lshlrev_b32 v240, 16, v71
  v_and_b32 v241, 0xffff0000, v71
  v_lshlrev_b32 v242, 16, v47
  v_and_b32 v243, 0xffff0000, v47
  v_mul_f32 v240, v240, v242
  v_mul_f32 v241, v241, v243
  v_cvt_pk_bf16_f32 v242, v240, v241
  v_lshlrev_b32 v240, 16, v242
  v_and_b32 v241, 0xffff0000, v242
  v_fma_f32 v182, 2.0, v182, v240
  v_fma_f32 v183, 2.0, v183, v241
  v_mul_f32 v182, v42, v182
  v_mul_f32 v183, v42, v183
  v_accvgpr_read_b32 v196, a40
  v_accvgpr_read_b32 v197, a41
  v_accvgpr_read_b32 v198, a42
  v_accvgpr_read_b32 v199, a43
  v_lshlrev_b32 v236, 16, v72
  v_and_b32 v237, 0xffff0000, v72
  v_lshlrev_b32 v238, 16, v48
  v_and_b32 v239, 0xffff0000, v48
  v_mul_f32 v236, v236, v238
  v_mul_f32 v237, v237, v239
  v_cvt_pk_bf16_f32 v238, v236, v237
  v_lshlrev_b32 v236, 16, v238
  v_and_b32 v237, 0xffff0000, v238
  v_fma_f32 v196, 2.0, v196, v236
  v_fma_f32 v197, 2.0, v197, v237
  v_mul_f32 v196, v42, v196
  v_mul_f32 v197, v42, v197
  v_lshlrev_b32 v240, 16, v73
  v_and_b32 v241, 0xffff0000, v73
  v_lshlrev_b32 v242, 16, v49
  v_and_b32 v243, 0xffff0000, v49
  v_mul_f32 v240, v240, v242
  v_mul_f32 v241, v241, v243
  v_cvt_pk_bf16_f32 v242, v240, v241
  v_lshlrev_b32 v240, 16, v242
  v_and_b32 v241, 0xffff0000, v242
  v_fma_f32 v198, 2.0, v198, v240
  v_fma_f32 v199, 2.0, v199, v241
  v_mul_f32 v198, v42, v198
  v_mul_f32 v199, v42, v199
  v_accvgpr_read_b32 v212, a56
  v_accvgpr_read_b32 v213, a57
  v_accvgpr_read_b32 v214, a58
  v_accvgpr_read_b32 v215, a59
  v_lshlrev_b32 v236, 16, v74
  v_and_b32 v237, 0xffff0000, v74
  v_lshlrev_b32 v238, 16, v50
  v_and_b32 v239, 0xffff0000, v50
  v_mul_f32 v236, v236, v238
  v_mul_f32 v237, v237, v239
  v_cvt_pk_bf16_f32 v238, v236, v237
  v_lshlrev_b32 v236, 16, v238
  v_and_b32 v237, 0xffff0000, v238
  v_fma_f32 v212, 2.0, v212, v236
  v_fma_f32 v213, 2.0, v213, v237
  v_mul_f32 v212, v42, v212
  v_mul_f32 v213, v42, v213
  v_lshlrev_b32 v240, 16, v75
  v_and_b32 v241, 0xffff0000, v75
  v_lshlrev_b32 v242, 16, v51
  v_and_b32 v243, 0xffff0000, v51
  v_mul_f32 v240, v240, v242
  v_mul_f32 v241, v241, v243
  v_cvt_pk_bf16_f32 v242, v240, v241
  v_lshlrev_b32 v240, 16, v242
  v_and_b32 v241, 0xffff0000, v242
  v_fma_f32 v214, 2.0, v214, v240
  v_fma_f32 v215, 2.0, v215, v241
  v_mul_f32 v214, v42, v214
  v_mul_f32 v215, v42, v215
  v_sub_f32 v223, 1.0, v43
  v_cvt_pk_bf16_f32 v223, v223, v223
  v_lshlrev_b32 v223, 16, v223
  v_accvgpr_read_b32 v168, a12
  v_accvgpr_read_b32 v169, a13
  v_accvgpr_read_b32 v170, a14
  v_accvgpr_read_b32 v171, a15
  v_lshlrev_b32 v236, 16, v76
  v_and_b32 v237, 0xffff0000, v76
  v_lshlrev_b32 v238, 16, v44
  v_and_b32 v239, 0xffff0000, v44
  v_mul_f32 v236, v236, v238
  v_mul_f32 v237, v237, v239
  v_cvt_pk_bf16_f32 v238, v236, v237
  v_lshlrev_b32 v236, 16, v238
  v_and_b32 v237, 0xffff0000, v238
  v_fma_f32 v168, 2.0, v168, v236
  v_fma_f32 v169, 2.0, v169, v237
  v_mul_f32 v168, v43, v168
  v_mul_f32 v169, v43, v169
  v_lshlrev_b32 v240, 16, v77
  v_and_b32 v241, 0xffff0000, v77
  v_lshlrev_b32 v242, 16, v45
  v_and_b32 v243, 0xffff0000, v45
  v_mul_f32 v240, v240, v242
  v_mul_f32 v241, v241, v243
  v_cvt_pk_bf16_f32 v242, v240, v241
  v_lshlrev_b32 v240, 16, v242
  v_and_b32 v241, 0xffff0000, v242
  v_fma_f32 v170, 2.0, v170, v240
  v_fma_f32 v171, 2.0, v171, v241
  v_mul_f32 v170, v43, v170
  v_mul_f32 v171, v43, v171
  v_accvgpr_read_b32 v184, a28
  v_accvgpr_read_b32 v185, a29
  v_accvgpr_read_b32 v186, a30
  v_accvgpr_read_b32 v187, a31
  v_lshlrev_b32 v236, 16, v78
  v_and_b32 v237, 0xffff0000, v78
  v_lshlrev_b32 v238, 16, v46
  v_and_b32 v239, 0xffff0000, v46
  v_mul_f32 v236, v236, v238
  v_mul_f32 v237, v237, v239
  v_cvt_pk_bf16_f32 v238, v236, v237
  v_lshlrev_b32 v236, 16, v238
  v_and_b32 v237, 0xffff0000, v238
  v_fma_f32 v184, 2.0, v184, v236
  v_fma_f32 v185, 2.0, v185, v237
  v_mul_f32 v184, v43, v184
  v_mul_f32 v185, v43, v185
  v_lshlrev_b32 v240, 16, v79
  v_and_b32 v241, 0xffff0000, v79
  v_lshlrev_b32 v242, 16, v47
  v_and_b32 v243, 0xffff0000, v47
  v_mul_f32 v240, v240, v242
  v_mul_f32 v241, v241, v243
  v_cvt_pk_bf16_f32 v242, v240, v241
  v_lshlrev_b32 v240, 16, v242
  v_and_b32 v241, 0xffff0000, v242
  v_fma_f32 v186, 2.0, v186, v240
  v_fma_f32 v187, 2.0, v187, v241
  v_mul_f32 v186, v43, v186
  v_mul_f32 v187, v43, v187
  v_accvgpr_read_b32 v200, a44
  v_accvgpr_read_b32 v201, a45
  v_accvgpr_read_b32 v202, a46
  v_accvgpr_read_b32 v203, a47
  v_lshlrev_b32 v236, 16, v80
  v_and_b32 v237, 0xffff0000, v80
  v_lshlrev_b32 v238, 16, v48
  v_and_b32 v239, 0xffff0000, v48
  v_mul_f32 v236, v236, v238
  v_mul_f32 v237, v237, v239
  v_cvt_pk_bf16_f32 v238, v236, v237
  v_lshlrev_b32 v236, 16, v238
  v_and_b32 v237, 0xffff0000, v238
  v_fma_f32 v200, 2.0, v200, v236
  v_fma_f32 v201, 2.0, v201, v237
  v_mul_f32 v200, v43, v200
  v_mul_f32 v201, v43, v201
  v_lshlrev_b32 v240, 16, v81
  v_and_b32 v241, 0xffff0000, v81
  v_lshlrev_b32 v242, 16, v49
  v_and_b32 v243, 0xffff0000, v49
  v_mul_f32 v240, v240, v242
  v_mul_f32 v241, v241, v243
  v_cvt_pk_bf16_f32 v242, v240, v241
  v_lshlrev_b32 v240, 16, v242
  v_and_b32 v241, 0xffff0000, v242
  v_fma_f32 v202, 2.0, v202, v240
  v_fma_f32 v203, 2.0, v203, v241
  v_mul_f32 v202, v43, v202
  v_mul_f32 v203, v43, v203
  v_accvgpr_read_b32 v216, a60
  v_accvgpr_read_b32 v217, a61
  v_accvgpr_read_b32 v218, a62
  v_accvgpr_read_b32 v219, a63
  v_lshlrev_b32 v236, 16, v82
  v_and_b32 v237, 0xffff0000, v82
  v_lshlrev_b32 v238, 16, v50
  v_and_b32 v239, 0xffff0000, v50
  v_mul_f32 v236, v236, v238
  v_mul_f32 v237, v237, v239
  v_cvt_pk_bf16_f32 v238, v236, v237
  v_lshlrev_b32 v236, 16, v238
  v_and_b32 v237, 0xffff0000, v238
  v_fma_f32 v216, 2.0, v216, v236
  v_fma_f32 v217, 2.0, v217, v237
  v_mul_f32 v216, v43, v216
  v_mul_f32 v217, v43, v217
  v_lshlrev_b32 v240, 16, v83
  v_and_b32 v241, 0xffff0000, v83
  v_lshlrev_b32 v242, 16, v51
  v_and_b32 v243, 0xffff0000, v51
  v_mul_f32 v240, v240, v242
  v_mul_f32 v241, v241, v243
  v_cvt_pk_bf16_f32 v242, v240, v241
  v_lshlrev_b32 v240, 16, v242
  v_and_b32 v241, 0xffff0000, v242
  v_fma_f32 v218, 2.0, v218, v240
  v_fma_f32 v219, 2.0, v219, v241
  v_mul_f32 v218, v43, v218
  v_mul_f32 v219, v43, v219
  s_and_b32 s3, s43, 31
  s_lshl_b32 s3, 1, s3
  s_lshr_b32 s4, s43, 5
  s_lshl_b32 s4, s4, 2
  v_mov_b32 v28, s4
  s_mov_b32 s5, 0
K3_poll:
  buffer_load_dword v29, v28, s[48:51], 0 offen sc1
  s_waitcnt vmcnt(0)
  v_readfirstlane_b32 s6, v29
  s_and_b32 s6, s6, s3
  s_cmp_eq_u32 s6, s3
  s_cbranch_scc1 K3_poll_done
  s_sleep 2
  s_add_u32 s5, s5, 1
  s_cmp_lt_u32 s5, 0x80000
  s_cbranch_scc1 K3_poll
K3_poll_done:
  v_add_u32 v28, 0x0, v32
  buffer_load_dwordx4 v[84:87], v28, s[8:11], 0 offen offset:0 sc1
  v_add_u32 v28, 0x1000, v32
  buffer_load_dwordx4 v[100:103], v28, s[8:11], 0 offen offset:0 sc1
  v_add_u32 v28, 0x2000, v32
  buffer_load_dwordx4 v[116:119], v28, s[8:11], 0 offen offset:0 sc1
  v_add_u32 v28, 0x3000, v32
  buffer_load_dwordx4 v[132:135], v28, s[8:11], 0 offen offset:0 sc1
  v_add_u32 v28, 0x0, v32
  buffer_load_dwordx4 v[88:91], v28, s[8:11], 0 offen offset:1024 sc1
  v_add_u32 v28, 0x1000, v32
  buffer_load_dwordx4 v[104:107], v28, s[8:11], 0 offen offset:1024 sc1
  v_add_u32 v28, 0x2000, v32
  buffer_load_dwordx4 v[120:123], v28, s[8:11], 0 offen offset:1024 sc1
  v_add_u32 v28, 0x3000, v32
  buffer_load_dwordx4 v[136:139], v28, s[8:11], 0 offen offset:1024 sc1
  v_add_u32 v28, 0x0, v32
  buffer_load_dwordx4 v[92:95], v28, s[8:11], 0 offen offset:2048 sc1
  v_add_u32 v28, 0x1000, v32
  buffer_load_dwordx4 v[108:111], v28, s[8:11], 0 offen offset:2048 sc1
  v_add_u32 v28, 0x2000, v32
  buffer_load_dwordx4 v[124:127], v28, s[8:11], 0 offen offset:2048 sc1
  v_add_u32 v28, 0x3000, v32
  buffer_load_dwordx4 v[140:143], v28, s[8:11], 0 offen offset:2048 sc1
  v_add_u32 v28, 0x0, v32
  buffer_load_dwordx4 v[96:99], v28, s[8:11], 0 offen offset:3072 sc1
  v_add_u32 v28, 0x1000, v32
  buffer_load_dwordx4 v[112:115], v28, s[8:11], 0 offen offset:3072 sc1
  v_add_u32 v28, 0x2000, v32
  buffer_load_dwordx4 v[128:131], v28, s[8:11], 0 offen offset:3072 sc1
  v_add_u32 v28, 0x3000, v32
  buffer_load_dwordx4 v[144:147], v28, s[8:11], 0 offen offset:3072 sc1
  v_accvgpr_read_b32 v236, a64
  v_accvgpr_read_b32 v237, a65
  v_accvgpr_read_b32 v238, a66
  v_accvgpr_read_b32 v239, a67
  s_waitcnt vmcnt(15)
  v_add_f32 v84, v84, v236
  v_add_f32 v85, v85, v237
  v_add_f32 v86, v86, v238
  v_add_f32 v87, v87, v239
  v_cvt_pk_bf16_f32 v242, v84, v85
  v_lshlrev_b32 v240, 16, v242
  v_and_b32 v241, 0xffff0000, v242
  v_mul_f32 v240, v220, v240
  v_mul_f32 v241, v220, v241
  v_cvt_pk_bf16_f32 v242, v240, v241
  v_lshlrev_b32 v240, 16, v242
  v_and_b32 v241, 0xffff0000, v242
  v_add_f32 v156, v156, v240
  v_add_f32 v157, v157, v241
  v_cvt_pk_bf16_f32 v245, v86, v87
  v_lshlrev_b32 v243, 16, v245
  v_and_b32 v244, 0xffff0000, v245
  v_mul_f32 v243, v220, v243
  v_mul_f32 v244, v220, v244
  v_cvt_pk_bf16_f32 v245, v243, v244
  v_lshlrev_b32 v243, 16, v245
  v_and_b32 v244, 0xffff0000, v245
  v_add_f32 v158, v158, v243
  v_add_f32 v159, v159, v244
  buffer_store_dwordx4 v[156:159], v30, s[24:27], 0 offen offset:0
  v_accvgpr_read_b32 v236, a80
  v_accvgpr_read_b32 v237, a81
  v_accvgpr_read_b32 v238, a82
  v_accvgpr_read_b32 v239, a83
  s_waitcnt vmcnt(15)
  v_add_f32 v100, v100, v236
  v_add_f32 v101, v101, v237
  v_add_f32 v102, v102, v238
  v_add_f32 v103, v103, v239
  v_cvt_pk_bf16_f32 v242, v100, v101
  v_lshlrev_b32 v240, 16, v242
  v_and_b32 v241, 0xffff0000, v242
  v_mul_f32 v240, v220, v240
  v_mul_f32 v241, v220, v241
  v_cvt_pk_bf16_f32 v242, v240, v241
  v_lshlrev_b32 v240, 16, v242
  v_and_b32 v241, 0xffff0000, v242
  v_add_f32 v172, v172, v240
  v_add_f32 v173, v173, v241
  v_cvt_pk_bf16_f32 v245, v102, v103
  v_lshlrev_b32 v243, 16, v245
  v_and_b32 v244, 0xffff0000, v245
  v_mul_f32 v243, v220, v243
  v_mul_f32 v244, v220, v244
  v_cvt_pk_bf16_f32 v245, v243, v244
  v_lshlrev_b32 v243, 16, v245
  v_and_b32 v244, 0xffff0000, v245
  v_add_f32 v174, v174, v243
  v_add_f32 v175, v175, v244
  buffer_store_dwordx4 v[172:175], v30, s[24:27], 0 offen offset:64
  v_accvgpr_read_b32 v236, a96
  v_accvgpr_read_b32 v237, a97
  v_accvgpr_read_b32 v238, a98
  v_accvgpr_read_b32 v239, a99
  s_waitcnt vmcnt(15)
  v_add_f32 v116, v116, v236
  v_add_f32 v117, v117, v237
  v_add_f32 v118, v118, v238
  v_add_f32 v119, v119, v239
  v_cvt_pk_bf16_f32 v242, v116, v117
  v_lshlrev_b32 v240, 16, v242
  v_and_b32 v241, 0xffff0000, v242
  v_mul_f32 v240, v220, v240
  v_mul_f32 v241, v220, v241
  v_cvt_pk_bf16_f32 v242, v240, v241
  v_lshlrev_b32 v240, 16, v242
  v_and_b32 v241, 0xffff0000, v242
  v_add_f32 v188, v188, v240
  v_add_f32 v189, v189, v241
  v_cvt_pk_bf16_f32 v245, v118, v119
  v_lshlrev_b32 v243, 16, v245
  v_and_b32 v244, 0xffff0000, v245
  v_mul_f32 v243, v220, v243
  v_mul_f32 v244, v220, v244
  v_cvt_pk_bf16_f32 v245, v243, v244
  v_lshlrev_b32 v243, 16, v245
  v_and_b32 v244, 0xffff0000, v245
  v_add_f32 v190, v190, v243
  v_add_f32 v191, v191, v244
  buffer_store_dwordx4 v[188:191], v30, s[24:27], 0 offen offset:128
  v_accvgpr_read_b32 v236, a112
  v_accvgpr_read_b32 v237, a113
  v_accvgpr_read_b32 v238, a114
  v_accvgpr_read_b32 v239, a115
  s_waitcnt vmcnt(15)
  v_add_f32 v132, v132, v236
  v_add_f32 v133, v133, v237
  v_add_f32 v134, v134, v238
  v_add_f32 v135, v135, v239
  v_cvt_pk_bf16_f32 v242, v132, v133
  v_lshlrev_b32 v240, 16, v242
  v_and_b32 v241, 0xffff0000, v242
  v_mul_f32 v240, v220, v240
  v_mul_f32 v241, v220, v241
  v_cvt_pk_bf16_f32 v242, v240, v241
  v_lshlrev_b32 v240, 16, v242
  v_and_b32 v241, 0xffff0000, v242
  v_add_f32 v204, v204, v240
  v_add_f32 v205, v205, v241
  v_cvt_pk_bf16_f32 v245, v134, v135
  v_lshlrev_b32 v243, 16, v245
  v_and_b32 v244, 0xffff0000, v245
  v_mul_f32 v243, v220, v243
  v_mul_f32 v244, v220, v244
  v_cvt_pk_bf16_f32 v245, v243, v244
  v_lshlrev_b32 v243, 16, v245
  v_and_b32 v244, 0xffff0000, v245
  v_add_f32 v206, v206, v243
  v_add_f32 v207, v207, v244
  buffer_store_dwordx4 v[204:207], v30, s[24:27], 0 offen offset:192
  v_add_u32 v30, 0x10000, v30
  v_accvgpr_read_b32 v236, a68
  v_accvgpr_read_b32 v237, a69
  v_accvgpr_read_b32 v238, a70
  v_accvgpr_read_b32 v239, a71
  s_waitcnt vmcnt(15)
  v_add_f32 v88, v88, v236
  v_add_f32 v89, v89, v237
  v_add_f32 v90, v90, v238
  v_add_f32 v91, v91, v239
  v_cvt_pk_bf16_f32 v242, v88, v89
  v_lshlrev_b32 v240, 16, v242
  v_and_b32 v241, 0xffff0000, v242
  v_mul_f32 v240, v221, v240
  v_mul_f32 v241, v221, v241
  v_cvt_pk_bf16_f32 v242, v240, v241
  v_lshlrev_b32 v240, 16, v242
  v_and_b32 v241, 0xffff0000, v242
  v_add_f32 v160, v160, v240
  v_add_f32 v161, v161, v241
  v_cvt_pk_bf16_f32 v245, v90, v91
  v_lshlrev_b32 v243, 16, v245
  v_and_b32 v244, 0xffff0000, v245
  v_mul_f32 v243, v221, v243
  v_mul_f32 v244, v221, v244
  v_cvt_pk_bf16_f32 v245, v243, v244
  v_lshlrev_b32 v243, 16, v245
  v_and_b32 v244, 0xffff0000, v245
  v_add_f32 v162, v162, v243
  v_add_f32 v163, v163, v244
  buffer_store_dwordx4 v[160:163], v30, s[24:27], 0 offen offset:0
  v_accvgpr_read_b32 v236, a84
  v_accvgpr_read_b32 v237, a85
  v_accvgpr_read_b32 v238, a86
  v_accvgpr_read_b32 v239, a87
  s_waitcnt vmcnt(15)
  v_add_f32 v104, v104, v236
  v_add_f32 v105, v105, v237
  v_add_f32 v106, v106, v238
  v_add_f32 v107, v107, v239
  v_cvt_pk_bf16_f32 v242, v104, v105
  v_lshlrev_b32 v240, 16, v242
  v_and_b32 v241, 0xffff0000, v242
  v_mul_f32 v240, v221, v240
  v_mul_f32 v241, v221, v241
  v_cvt_pk_bf16_f32 v242, v240, v241
  v_lshlrev_b32 v240, 16, v242
  v_and_b32 v241, 0xffff0000, v242
  v_add_f32 v176, v176, v240
  v_add_f32 v177, v177, v241
  v_cvt_pk_bf16_f32 v245, v106, v107
  v_lshlrev_b32 v243, 16, v245
  v_and_b32 v244, 0xffff0000, v245
  v_mul_f32 v243, v221, v243
  v_mul_f32 v244, v221, v244
  v_cvt_pk_bf16_f32 v245, v243, v244
  v_lshlrev_b32 v243, 16, v245
  v_and_b32 v244, 0xffff0000, v245
  v_add_f32 v178, v178, v243
  v_add_f32 v179, v179, v244
  buffer_store_dwordx4 v[176:179], v30, s[24:27], 0 offen offset:64
  v_accvgpr_read_b32 v236, a100
  v_accvgpr_read_b32 v237, a101
  v_accvgpr_read_b32 v238, a102
  v_accvgpr_read_b32 v239, a103
  s_waitcnt vmcnt(15)
  v_add_f32 v120, v120, v236
  v_add_f32 v121, v121, v237
  v_add_f32 v122, v122, v238
  v_add_f32 v123, v123, v239
  v_cvt_pk_bf16_f32 v242, v120, v121
  v_lshlrev_b32 v240, 16, v242
  v_and_b32 v241, 0xffff0000, v242
  v_mul_f32 v240, v221, v240
  v_mul_f32 v241, v221, v241
  v_cvt_pk_bf16_f32 v242, v240, v241
  v_lshlrev_b32 v240, 16, v242
  v_and_b32 v241, 0xffff0000, v242
  v_add_f32 v192, v192, v240
  v_add_f32 v193, v193, v241
  v_cvt_pk_bf16_f32 v245, v122, v123
  v_lshlrev_b32 v243, 16, v245
  v_and_b32 v244, 0xffff0000, v245
  v_mul_f32 v243, v221, v243
  v_mul_f32 v244, v221, v244
  v_cvt_pk_bf16_f32 v245, v243, v244
  v_lshlrev_b32 v243, 16, v245
  v_and_b32 v244, 0xffff0000, v245
  v_add_f32 v194, v194, v243
  v_add_f32 v195, v195, v244
  buffer_store_dwordx4 v[192:195], v30, s[24:27], 0 offen offset:128
  v_accvgpr_read_b32 v236, a116
  v_accvgpr_read_b32 v237, a117
  v_accvgpr_read_b32 v238, a118
  v_accvgpr_read_b32 v239, a119
  s_waitcnt vmcnt(15)
  v_add_f32 v136, v136, v236
  v_add_f32 v137, v137, v237
  v_add_f32 v138, v138, v238
  v_add_f32 v139, v139, v239
  v_cvt_pk_bf16_f32 v242, v136, v137
  v_lshlrev_b32 v240, 16, v242
  v_and_b32 v241, 0xffff0000, v242
  v_mul_f32 v240, v221, v240
  v_mul_f32 v241, v221, v241
  v_cvt_pk_bf16_f32 v242, v240, v241
  v_lshlrev_b32 v240, 16, v242
  v_and_b32 v241, 0xffff0000, v242
  v_add_f32 v208, v208, v240
  v_add_f32 v209, v209, v241
  v_cvt_pk_bf16_f32 v245, v138, v139
  v_lshlrev_b32 v243, 16, v245
  v_and_b32 v244, 0xffff0000, v245
  v_mul_f32 v243, v221, v243
  v_mul_f32 v244, v221, v244
  v_cvt_pk_bf16_f32 v245, v243, v244
  v_lshlrev_b32 v243, 16, v245
  v_and_b32 v244, 0xffff0000, v245
  v_add_f32 v210, v210, v243
  v_add_f32 v211, v211, v244
  buffer_store_dwordx4 v[208:211], v30, s[24:27], 0 offen offset:192
  v_add_u32 v30, 0x10000, v30
  v_accvgpr_read_b32 v236, a72
  v_accvgpr_read_b32 v237, a73
  v_accvgpr_read_b32 v238, a74
  v_accvgpr_read_b32 v239, a75
  s_waitcnt vmcnt(15)
  v_add_f32 v92, v92, v236
  v_add_f32 v93, v93, v237
  v_add_f32 v94, v94, v238
  v_add_f32 v95, v95, v239
  v_cvt_pk_bf16_f32 v242, v92, v93
  v_lshlrev_b32 v240, 16, v242
  v_and_b32 v241, 0xffff0000, v242
  v_mul_f32 v240, v222, v240
  v_mul_f32 v241, v222, v241
  v_cvt_pk_bf16_f32 v242, v240, v241
  v_lshlrev_b32 v240, 16, v242
  v_and_b32 v241, 0xffff0000, v242
  v_add_f32 v164, v164, v240
  v_add_f32 v165, v165, v241
  v_cvt_pk_bf16_f32 v245, v94, v95
  v_lshlrev_b32 v243, 16, v245
  v_and_b32 v244, 0xffff0000, v245
  v_mul_f32 v243, v222, v243
  v_mul_f32 v244, v222, v244
  v_cvt_pk_bf16_f32 v245, v243, v244
  v_lshlrev_b32 v243, 16, v245
  v_and_b32 v244, 0xffff0000, v245
  v_add_f32 v166, v166, v243
  v_add_f32 v167, v167, v244
  buffer_store_dwordx4 v[164:167], v30, s[24:27], 0 offen offset:0
  v_accvgpr_read_b32 v236, a88
  v_accvgpr_read_b32 v237, a89
  v_accvgpr_read_b32 v238, a90
  v_accvgpr_read_b32 v239, a91
  s_waitcnt vmcnt(15)
  v_add_f32 v108, v108, v236
  v_add_f32 v109, v109, v237
  v_add_f32 v110, v110, v238
  v_add_f32 v111, v111, v239
  v_cvt_pk_bf16_f32 v242, v108, v109
  v_lshlrev_b32 v240, 16, v242
  v_and_b32 v241, 0xffff0000, v242
  v_mul_f32 v240, v222, v240
  v_mul_f32 v241, v222, v241
  v_cvt_pk_bf16_f32 v242, v240, v241
  v_lshlrev_b32 v240, 16, v242
  v_and_b32 v241, 0xffff0000, v242
  v_add_f32 v180, v180, v240
  v_add_f32 v181, v181, v241
  v_cvt_pk_bf16_f32 v245, v110, v111
  v_lshlrev_b32 v243, 16, v245
  v_and_b32 v244, 0xffff0000, v245
  v_mul_f32 v243, v222, v243
  v_mul_f32 v244, v222, v244
  v_cvt_pk_bf16_f32 v245, v243, v244
  v_lshlrev_b32 v243, 16, v245
  v_and_b32 v244, 0xffff0000, v245
  v_add_f32 v182, v182, v243
  v_add_f32 v183, v183, v244
  buffer_store_dwordx4 v[180:183], v30, s[24:27], 0 offen offset:64
  v_accvgpr_read_b32 v236, a104
  v_accvgpr_read_b32 v237, a105
  v_accvgpr_read_b32 v238, a106
  v_accvgpr_read_b32 v239, a107
  s_waitcnt vmcnt(15)
  v_add_f32 v124, v124, v236
  v_add_f32 v125, v125, v237
  v_add_f32 v126, v126, v238
  v_add_f32 v127, v127, v239
  v_cvt_pk_bf16_f32 v242, v124, v125
  v_lshlrev_b32 v240, 16, v242
  v_and_b32 v241, 0xffff0000, v242
  v_mul_f32 v240, v222, v240
  v_mul_f32 v241, v222, v241
  v_cvt_pk_bf16_f32 v242, v240, v241
  v_lshlrev_b32 v240, 16, v242
  v_and_b32 v241, 0xffff0000, v242
  v_add_f32 v196, v196, v240
  v_add_f32 v197, v197, v241
  v_cvt_pk_bf16_f32 v245, v126, v127
  v_lshlrev_b32 v243, 16, v245
  v_and_b32 v244, 0xffff0000, v245
  v_mul_f32 v243, v222, v243
  v_mul_f32 v244, v222, v244
  v_cvt_pk_bf16_f32 v245, v243, v244
  v_lshlrev_b32 v243, 16, v245
  v_and_b32 v244, 0xffff0000, v245
  v_add_f32 v198, v198, v243
  v_add_f32 v199, v199, v244
  buffer_store_dwordx4 v[196:199], v30, s[24:27], 0 offen offset:128
  v_accvgpr_read_b32 v236, a120
  v_accvgpr_read_b32 v237, a121
  v_accvgpr_read_b32 v238, a122
  v_accvgpr_read_b32 v239, a123
  s_waitcnt vmcnt(15)
  v_add_f32 v140, v140, v236
  v_add_f32 v141, v141, v237
  v_add_f32 v142, v142, v238
  v_add_f32 v143, v143, v239
  v_cvt_pk_bf16_f32 v242, v140, v141
  v_lshlrev_b32 v240, 16, v242
  v_and_b32 v241, 0xffff0000, v242
  v_mul_f32 v240, v222, v240
  v_mul_f32 v241, v222, v241
  v_cvt_pk_bf16_f32 v242, v240, v241
  v_lshlrev_b32 v240, 16, v242
  v_and_b32 v241, 0xffff0000, v242
  v_add_f32 v212, v212, v240
  v_add_f32 v213, v213, v241
  v_cvt_pk_bf16_f32 v245, v142, v143
  v_lshlrev_b32 v243, 16, v245
  v_and_b32 v244, 0xffff0000, v245
  v_mul_f32 v243, v222, v243
  v_mul_f32 v244, v222, v244
  v_cvt_pk_bf16_f32 v245, v243, v244
  v_lshlrev_b32 v243, 16, v245
  v_and_b32 v244, 0xffff0000, v245
  v_add_f32 v214, v214, v243
  v_add_f32 v215, v215, v244
  buffer_store_dwordx4 v[212:215], v30, s[24:27], 0 offen offset:192
  v_add_u32 v30, 0x10000, v30
  v_accvgpr_read_b32 v236, a76
  v_accvgpr_read_b32 v237, a77
  v_accvgpr_read_b32 v238, a78
  v_accvgpr_read_b32 v239, a79
  s_waitcnt vmcnt(15)
  v_add_f32 v96, v96, v236
  v_add_f32 v97, v97, v237
  v_add_f32 v98, v98, v238
  v_add_f32 v99, v99, v239
  v_cvt_pk_bf16_f32 v242, v96, v97
  v_lshlrev_b32 v240, 16, v242
  v_and_b32 v241, 0xffff0000, v242
  v_mul_f32 v240, v223, v240
  v_mul_f32 v241, v223, v241
  v_cvt_pk_bf16_f32 v242, v240, v241
  v_lshlrev_b32 v240, 16, v242
  v_and_b32 v241, 0xffff0000, v242
  v_add_f32 v168, v168, v240
  v_add_f32 v169, v169, v241
  v_cvt_pk_bf16_f32 v245, v98, v99
  v_lshlrev_b32 v243, 16, v245
  v_and_b32 v244, 0xffff0000, v245
  v_mul_f32 v243, v223, v243
  v_mul_f32 v244, v223, v244
  v_cvt_pk_bf16_f32 v245, v243, v244
  v_lshlrev_b32 v243, 16, v245
  v_and_b32 v244, 0xffff0000, v245
  v_add_f32 v170, v170, v243
  v_add_f32 v171, v171, v244
  buffer_store_dwordx4 v[168:171], v30, s[24:27], 0 offen offset:0
  v_accvgpr_read_b32 v236, a92
  v_accvgpr_read_b32 v237, a93
  v_accvgpr_read_b32 v238, a94
  v_accvgpr_read_b32 v239, a95
  s_waitcnt vmcnt(15)
  v_add_f32 v112, v112, v236
  v_add_f32 v113, v113, v237
  v_add_f32 v114, v114, v238
  v_add_f32 v115, v115, v239
  v_cvt_pk_bf16_f32 v242, v112, v113
  v_lshlrev_b32 v240, 16, v242
  v_and_b32 v241, 0xffff0000, v242
  v_mul_f32 v240, v223, v240
  v_mul_f32 v241, v223, v241
  v_cvt_pk_bf16_f32 v242, v240, v241
  v_lshlrev_b32 v240, 16, v242
  v_and_b32 v241, 0xffff0000, v242
  v_add_f32 v184, v184, v240
  v_add_f32 v185, v185, v241
  v_cvt_pk_bf16_f32 v245, v114, v115
  v_lshlrev_b32 v243, 16, v245
  v_and_b32 v244, 0xffff0000, v245
  v_mul_f32 v243, v223, v243
  v_mul_f32 v244, v223, v244
  v_cvt_pk_bf16_f32 v245, v243, v244
  v_lshlrev_b32 v243, 16, v245
  v_and_b32 v244, 0xffff0000, v245
  v_add_f32 v186, v186, v243
  v_add_f32 v187, v187, v244
  buffer_store_dwordx4 v[184:187], v30, s[24:27], 0 offen offset:64
  v_accvgpr_read_b32 v236, a108
  v_accvgpr_read_b32 v237, a109
  v_accvgpr_read_b32 v238, a110
  v_accvgpr_read_b32 v239, a111
  s_waitcnt vmcnt(15)
  v_add_f32 v128, v128, v236
  v_add_f32 v129, v129, v237
  v_add_f32 v130, v130, v238
  v_add_f32 v131, v131, v239
  v_cvt_pk_bf16_f32 v242, v128, v129
  v_lshlrev_b32 v240, 16, v242
  v_and_b32 v241, 0xffff0000, v242
  v_mul_f32 v240, v223, v240
  v_mul_f32 v241, v223, v241
  v_cvt_pk_bf16_f32 v242, v240, v241
  v_lshlrev_b32 v240, 16, v242
  v_and_b32 v241, 0xffff0000, v242
  v_add_f32 v200, v200, v240
  v_add_f32 v201, v201, v241
  v_cvt_pk_bf16_f32 v245, v130, v131
  v_lshlrev_b32 v243, 16, v245
  v_and_b32 v244, 0xffff0000, v245
  v_mul_f32 v243, v223, v243
  v_mul_f32 v244, v223, v244
  v_cvt_pk_bf16_f32 v245, v243, v244
  v_lshlrev_b32 v243, 16, v245
  v_and_b32 v244, 0xffff0000, v245
  v_add_f32 v202, v202, v243
  v_add_f32 v203, v203, v244
  buffer_store_dwordx4 v[200:203], v30, s[24:27], 0 offen offset:128
  v_accvgpr_read_b32 v236, a124
  v_accvgpr_read_b32 v237, a125
  v_accvgpr_read_b32 v238, a126
  v_accvgpr_read_b32 v239, a127
  s_waitcnt vmcnt(15)
  v_add_f32 v144, v144, v236
  v_add_f32 v145, v145, v237
  v_add_f32 v146, v146, v238
  v_add_f32 v147, v147, v239
  v_cvt_pk_bf16_f32 v242, v144, v145
  v_lshlrev_b32 v240, 16, v242
  v_and_b32 v241, 0xffff0000, v242
  v_mul_f32 v240, v223, v240
  v_mul_f32 v241, v223, v241
  v_cvt_pk_bf16_f32 v242, v240, v241
  v_lshlrev_b32 v240, 16, v242
  v_and_b32 v241, 0xffff0000, v242
  v_add_f32 v216, v216, v240
  v_add_f32 v217, v217, v241
  v_cvt_pk_bf16_f32 v245, v146, v147
  v_lshlrev_b32 v243, 16, v245
  v_and_b32 v244, 0xffff0000, v245
  v_mul_f32 v243, v223, v243
  v_mul_f32 v244, v223, v244
  v_cvt_pk_bf16_f32 v245, v243, v244
  v_lshlrev_b32 v243, 16, v245
  v_and_b32 v244, 0xffff0000, v245
  v_add_f32 v218, v218, v243
  v_add_f32 v219, v219, v244
  buffer_store_dwordx4 v[216:219], v30, s[24:27], 0 offen offset:192
  v_add_u32 v30, 0x10000, v30
K3_done:
  s_endpgm
.section .rodata,"a"
.p2align 6
.amdhsa_kernel k1_kernel
  .amdhsa_next_free_vgpr 256
  .amdhsa_next_free_sgpr 102
  .amdhsa_accum_offset 128
  .amdhsa_group_segment_fixed_size 0
  .amdhsa_kernarg_size 136
  .amdhsa_user_sgpr_count 2
  .amdhsa_user_sgpr_kernarg_segment_ptr 1
  .amdhsa_system_sgpr_workgroup_id_x 1
.end_amdhsa_kernel
.p2align 6
.amdhsa_kernel k3_kernel
  .amdhsa_next_free_vgpr 384
  .amdhsa_next_free_sgpr 102
  .amdhsa_accum_offset 256
  .amdhsa_group_segment_fixed_size 0
  .amdhsa_kernarg_size 136
  .amdhsa_user_sgpr_count 2
  .amdhsa_user_sgpr_kernarg_segment_ptr 1
  .amdhsa_system_sgpr_workgroup_id_x 1
.end_amdhsa_kernel
```
